```python
import torch

def _softmax(x, axis=-1):
    return torch.softmax(x, dim=axis)

def _gelu(x):
    return torch.nn.functional.gelu(x, approximate='tanh')

def _silu(x):
    return torch.nn.functional.silu(x)

def _sigmoid(x):
    return torch.sigmoid(x)

def _layernorm(x, axis=-1, eps=1e-05):
    m = x.mean(dim=axis, keepdim=True)
    v = x.var(dim=axis, keepdim=True, unbiased=False)
    return (x - m) / torch.sqrt(v + eps)

def _scatter_add(tgt, idx, src, axis=0):
    return tgt.clone().index_add_(axis, idx, src)

def _segment_sum(src, seg, n):
    out = torch.zeros((n,) + src.shape[1:], dtype=src.dtype)
    return out.index_add_(0, seg, src)

def _pad(x, pw):
    flat = tuple((v for pair in reversed(pw) for v in pair))
    return torch.nn.functional.pad(x, flat)
kernel_name = 'adaLN_cond__ssm_conv_s4d__geglu_ffn__prompt'

def setup_inputs():

    _w = lambda a: (lambda t: t.to(torch.bfloat16) if t.is_floating_point() else t)(torch.as_tensor(a))

    def _A_setup():
        Bsz, L, D, N = (1, 2048, 640, 192)
        return {'u': _w((lambda *s: torch.randn(*s, dtype=torch.bfloat16) * 0.05)(Bsz, L, D)), 'log_A_real': _w((lambda *s: torch.randn(*s, dtype=torch.bfloat16) * 3.2)(D, N) * 0.5), 'A_imag': _w((lambda *s: torch.randn(*s, dtype=torch.bfloat16) * 0.1)(D, N) * 3.14), 'C_real': _w((lambda *s: torch.randn(*s, dtype=torch.bfloat16) * 0.4)(D, N) / N ** 0.5), 'C_imag': _w((lambda *s: torch.randn(*s, dtype=torch.bfloat16) * 0.4)(D, N) / N ** 0.5), 'log_dt': _w((lambda *s: torch.randn(*s, dtype=torch.bfloat16) * 0.1)(D) * 0.5 - 4.0), 'D_skip': _w((lambda *s: torch.randn(*s, dtype=torch.bfloat16) * 0.1)(D))}
    _A_in = _A_setup()

    def _B_setup():
        B, S, D, F = (1, 2048, 640, 1536)
        return {'x': _w((lambda *s: torch.randn(*s, dtype=torch.bfloat16) * 0.05)(B, S, D)), 'w_gate': _w((lambda *s: torch.randn(*s, dtype=torch.bfloat16) * 0.05)(D, F)), 'w_up': _w((lambda *s: torch.randn(*s, dtype=torch.bfloat16) * 0.05)(D, F)), 'w_down': _w((lambda *s: torch.randn(*s, dtype=torch.bfloat16) * 0.05)(F, D))}
    _B_in = _B_setup()
    return {'A_u': _A_in['u'], 'A_log_A_real': _A_in['log_A_real'], 'A_A_imag': _A_in['A_imag'], 'A_C_real': _A_in['C_real'], 'A_C_imag': _A_in['C_imag'], 'A_log_dt': _A_in['log_dt'], 'A_D_skip': _A_in['D_skip'], 'B_x': _B_in['x'], 'B_w_gate': _B_in['w_gate'], 'B_w_up': _B_in['w_up'], 'B_w_down': _B_in['w_down'], 'c': _w((lambda *s: torch.randn(*s, dtype=torch.bfloat16) * 0.2)(1, 640) * 8.0), 'w_mod': _w((lambda *s: torch.randn(*s, dtype=torch.bfloat16) * 0.2)(640, 6 * 640) * 640 ** (-0.5) * 8.0)}

def reference(A_u, A_log_A_real, A_A_imag, A_C_real, A_C_imag, A_log_dt, A_D_skip, B_x, B_w_gate, B_w_up, B_w_down, c, w_mod):

    def _A_ref(u, log_A_real, A_imag, C_real, C_imag, log_dt, D_skip):
        L = u.shape[1]
        dt = torch.exp(log_dt)
        A = -torch.exp(log_A_real) + 1j * A_imag
        C = (C_real + 1j * C_imag) * dt[:, None]
        pos = (lambda x, dt: x.to(dt))(torch.arange(L), log_dt.dtype)
        P = torch.exp((A * dt[:, None])[:, :, None] * pos[None, None, :])
        K = 2.0 * torch.einsum('dn,dnl->dl', C, P).real
        L2 = 2 * L
        u_t = (lambda x, *d: x.permute(*d))(u, 0, 2, 1)
        Kf = (lambda x, *a, **k: torch.fft.rfft(x.float(), *a, **k))(K, L2)
        Uf = (lambda x, *a, **k: torch.fft.rfft(x.float(), *a, **k))(u_t, L2)
        y = (lambda x, *a, **k: torch.fft.irfft(x, *a, **k).to(torch.bfloat16))(Uf * Kf[None, :, :], L2)[:, :, :L]
        y = (lambda x, *d: x.permute(*d))(y, 0, 2, 1)
        return y + u * D_skip[None, None, :]

    def _B_ref(x, w_gate, w_up, w_down):
        return _gelu(x @ w_gate) * (x @ w_up) @ w_down
    x = A_u
    mod = (_silu(c) @ w_mod).reshape(c.shape[0], 6, 1, -1)
    sa, ca, ga, sb, cb, gb = (mod[:, 0].clone(), mod[:, 1].clone(), mod[:, 2].clone(), mod[:, 3].clone(), mod[:, 4].clone(), mod[:, 5].clone())
    h = _layernorm(x, axis=-1) * (1 + ca) + sa
    x = x + ga * _A_ref(h, A_log_A_real, A_A_imag, A_C_real, A_C_imag, A_log_dt, A_D_skip)
    h = _layernorm(x, axis=-1) * (1 + cb) + sb
    x = x + gb * _B_ref(h, B_w_gate, B_w_up, B_w_down)
    return x
```

```asm
; @launch kernel=k1_kernel grid=(1048,1,1) block=(256,1,1) lds=27648
; @launch kernel=k2_kernel grid=(856,1,1) block=(256,1,1) lds=40960
; @launch kernel=k34_kernel grid=(256,1,1) block=(512,1,1) lds=159904
.amdgcn_target "amdgcn-amd-amdhsa--gfx950"
.text
.globl k1_kernel
.p2align 8
.type k1_kernel,@function
k1_kernel:
s_cmp_ge_u32 s2, 8
s_cbranch_scc1 k1_nowarm_1
s_getpc_b64 s[62:63]
k1_pc:
s_sub_u32 s62, s62, k1_pc-k1_kernel
s_subb_u32 s63, s63, 0
v_lshlrev_b32 v94, 7, v0
s_mov_b32 s64, code_end-k1_kernel
v_cmp_gt_u32 vcc, s64, v94
s_and_saveexec_b64 s[66:67], vcc
s_cbranch_execz k1_cp_2
global_load_dword v95, v94, s[62:63]
k1_cp_2:
s_mov_b64 exec, s[66:67]
v_add_u32 v94, 32768, v94
v_cmp_gt_u32 vcc, s64, v94
s_and_saveexec_b64 s[66:67], vcc
s_cbranch_execz k1_cp_3
global_load_dword v95, v94, s[62:63]
k1_cp_3:
s_mov_b64 exec, s[66:67]
v_add_u32 v94, 32768, v94
k1_nowarm_1:
s_cmp_lt_u32 s2, 640
s_cbranch_scc1 k1_roleK
s_cmp_lt_u32 s2, 760
s_cbranch_scc1 k1_roleG
s_cmp_lt_u32 s2, 920
s_cbranch_scc1 k1_roleT
s_cmp_lt_u32 s2, 1048
s_cbranch_scc1 k1_roleS
k1_exit:
s_endpgm
k1_roleG:
v_lshrrev_b32 v1, 6, v0
s_nop 0
v_readfirstlane_b32 s3, v1
s_load_dwordx4 s[4:7], s[0:1], 88
s_load_dwordx2 s[14:15], s[0:1], 120
s_sub_u32 s40, s2, 640
s_lshr_b32 s41, s40, 1
s_and_b32 s40, s40, 1
v_and_b32 v1, 7, v0
v_lshrrev_b32 v2, 3, v0
s_mul_i32 s43, s40, 320
v_add_u32 v3, s43, v2
v_mul_u32_u24 v4, 7680, v3
v_lshl_add_u32 v4, v1, 4, v4
v_lshlrev_b32 v3, 1, v3
s_lshl_b32 s42, s41, 7
s_waitcnt lgkmcnt(0)
s_mov_b32 s16, s4
s_mov_b32 s17, s5
s_mov_b32 s18, 0x500
s_mov_b32 s19, 0x20000
s_mov_b32 s20, s6
s_mov_b32 s21, s7
s_mov_b32 s22, 0x4b0000
s_mov_b32 s23, 0x20000
s_add_u32 s24, s14, 0x170000
s_addc_u32 s25, s15, 0
s_mov_b32 s26, 0x7800
s_mov_b32 s27, 0x20000
buffer_load_ushort v10, v3, s[16:19], 0 offen offset:0
buffer_load_ushort v11, v3, s[16:19], 0 offen offset:64
buffer_load_ushort v12, v3, s[16:19], 0 offen offset:128
buffer_load_ushort v13, v3, s[16:19], 0 offen offset:192
buffer_load_ushort v14, v3, s[16:19], 0 offen offset:256
buffer_load_ushort v15, v3, s[16:19], 0 offen offset:320
buffer_load_ushort v16, v3, s[16:19], 0 offen offset:384
buffer_load_ushort v17, v3, s[16:19], 0 offen offset:448
buffer_load_ushort v18, v3, s[16:19], 0 offen offset:512
buffer_load_ushort v19, v3, s[16:19], 0 offen offset:576
buffer_load_dwordx4 v[20:23], v4, s[20:23], s42 offen
s_add_u32 s42, s42, 245760
buffer_load_dwordx4 v[24:27], v4, s[20:23], s42 offen
s_add_u32 s42, s42, 245760
buffer_load_dwordx4 v[28:31], v4, s[20:23], s42 offen
s_add_u32 s42, s42, 245760
buffer_load_dwordx4 v[32:35], v4, s[20:23], s42 offen
s_add_u32 s42, s42, 245760
buffer_load_dwordx4 v[36:39], v4, s[20:23], s42 offen
s_add_u32 s42, s42, 245760
buffer_load_dwordx4 v[40:43], v4, s[20:23], s42 offen
s_add_u32 s42, s42, 245760
buffer_load_dwordx4 v[44:47], v4, s[20:23], s42 offen
s_add_u32 s42, s42, 245760
buffer_load_dwordx4 v[48:51], v4, s[20:23], s42 offen
s_add_u32 s42, s42, 245760
buffer_load_dwordx4 v[52:55], v4, s[20:23], s42 offen
s_add_u32 s42, s42, 245760
buffer_load_dwordx4 v[56:59], v4, s[20:23], s42 offen
s_waitcnt vmcnt(10)
v_lshlrev_b32 v10, 16, v10
v_lshlrev_b32 v11, 16, v11
v_lshlrev_b32 v12, 16, v12
v_lshlrev_b32 v13, 16, v13
v_lshlrev_b32 v14, 16, v14
v_lshlrev_b32 v15, 16, v15
v_lshlrev_b32 v16, 16, v16
v_lshlrev_b32 v17, 16, v17
v_lshlrev_b32 v18, 16, v18
v_lshlrev_b32 v19, 16, v19
v_mul_f32 v60, 0xbfb8aa3b, v10
v_mul_f32 v61, 0xbfb8aa3b, v11
v_mul_f32 v62, 0xbfb8aa3b, v12
v_mul_f32 v63, 0xbfb8aa3b, v13
v_mul_f32 v64, 0xbfb8aa3b, v14
v_mul_f32 v65, 0xbfb8aa3b, v15
v_mul_f32 v66, 0xbfb8aa3b, v16
v_mul_f32 v67, 0xbfb8aa3b, v17
v_mul_f32 v68, 0xbfb8aa3b, v18
v_mul_f32 v69, 0xbfb8aa3b, v19
v_exp_f32 v60, v60
v_exp_f32 v61, v61
v_exp_f32 v62, v62
v_exp_f32 v63, v63
v_exp_f32 v64, v64
v_exp_f32 v65, v65
v_exp_f32 v66, v66
v_exp_f32 v67, v67
v_exp_f32 v68, v68
v_exp_f32 v69, v69
v_add_f32 v60, 1.0, v60
v_add_f32 v61, 1.0, v61
v_add_f32 v62, 1.0, v62
v_add_f32 v63, 1.0, v63
v_add_f32 v64, 1.0, v64
v_add_f32 v65, 1.0, v65
v_add_f32 v66, 1.0, v66
v_add_f32 v67, 1.0, v67
v_add_f32 v68, 1.0, v68
v_add_f32 v69, 1.0, v69
v_rcp_f32 v60, v60
v_rcp_f32 v61, v61
v_rcp_f32 v62, v62
v_rcp_f32 v63, v63
v_rcp_f32 v64, v64
v_rcp_f32 v65, v65
v_rcp_f32 v66, v66
v_rcp_f32 v67, v67
v_rcp_f32 v68, v68
v_rcp_f32 v69, v69
v_mul_f32 v10, v10, v60
v_mul_f32 v11, v11, v61
v_mul_f32 v12, v12, v62
v_mul_f32 v13, v13, v63
v_mul_f32 v14, v14, v64
v_mul_f32 v15, v15, v65
v_mul_f32 v16, v16, v66
v_mul_f32 v17, v17, v67
v_mul_f32 v18, v18, v68
v_mul_f32 v19, v19, v69
v_cvt_pk_bf16_f32 v60, v10, v10
v_cvt_pk_bf16_f32 v61, v11, v11
v_cvt_pk_bf16_f32 v62, v12, v12
v_cvt_pk_bf16_f32 v63, v13, v13
v_cvt_pk_bf16_f32 v64, v14, v14
v_cvt_pk_bf16_f32 v65, v15, v15
v_cvt_pk_bf16_f32 v66, v16, v16
v_cvt_pk_bf16_f32 v67, v17, v17
v_cvt_pk_bf16_f32 v68, v18, v18
v_cvt_pk_bf16_f32 v69, v19, v19
v_lshlrev_b32 v10, 16, v60
v_lshlrev_b32 v11, 16, v61
v_lshlrev_b32 v12, 16, v62
v_lshlrev_b32 v13, 16, v63
v_lshlrev_b32 v14, 16, v64
v_lshlrev_b32 v15, 16, v65
v_lshlrev_b32 v16, 16, v66
v_lshlrev_b32 v17, 16, v67
v_lshlrev_b32 v18, 16, v68
v_lshlrev_b32 v19, 16, v69
v_mov_b32 v60, 0
v_mov_b32 v61, 0
v_mov_b32 v62, 0
v_mov_b32 v63, 0
v_mov_b32 v64, 0
v_mov_b32 v65, 0
v_mov_b32 v66, 0
v_mov_b32 v67, 0
s_waitcnt vmcnt(9)
v_lshlrev_b32 v70, 16, v20
v_and_b32 v71, 0xffff0000, v20
v_fmac_f32 v60, v10, v70
v_fmac_f32 v61, v10, v71
v_lshlrev_b32 v70, 16, v21
v_and_b32 v71, 0xffff0000, v21
v_fmac_f32 v62, v10, v70
v_fmac_f32 v63, v10, v71
v_lshlrev_b32 v70, 16, v22
v_and_b32 v71, 0xffff0000, v22
v_fmac_f32 v64, v10, v70
v_fmac_f32 v65, v10, v71
v_lshlrev_b32 v70, 16, v23
v_and_b32 v71, 0xffff0000, v23
v_fmac_f32 v66, v10, v70
v_fmac_f32 v67, v10, v71
s_waitcnt vmcnt(8)
v_lshlrev_b32 v70, 16, v24
v_and_b32 v71, 0xffff0000, v24
v_fmac_f32 v60, v11, v70
v_fmac_f32 v61, v11, v71
v_lshlrev_b32 v70, 16, v25
v_and_b32 v71, 0xffff0000, v25
v_fmac_f32 v62, v11, v70
v_fmac_f32 v63, v11, v71
v_lshlrev_b32 v70, 16, v26
v_and_b32 v71, 0xffff0000, v26
v_fmac_f32 v64, v11, v70
v_fmac_f32 v65, v11, v71
v_lshlrev_b32 v70, 16, v27
v_and_b32 v71, 0xffff0000, v27
v_fmac_f32 v66, v11, v70
v_fmac_f32 v67, v11, v71
s_waitcnt vmcnt(7)
v_lshlrev_b32 v70, 16, v28
v_and_b32 v71, 0xffff0000, v28
v_fmac_f32 v60, v12, v70
v_fmac_f32 v61, v12, v71
v_lshlrev_b32 v70, 16, v29
v_and_b32 v71, 0xffff0000, v29
v_fmac_f32 v62, v12, v70
v_fmac_f32 v63, v12, v71
v_lshlrev_b32 v70, 16, v30
v_and_b32 v71, 0xffff0000, v30
v_fmac_f32 v64, v12, v70
v_fmac_f32 v65, v12, v71
v_lshlrev_b32 v70, 16, v31
v_and_b32 v71, 0xffff0000, v31
v_fmac_f32 v66, v12, v70
v_fmac_f32 v67, v12, v71
s_waitcnt vmcnt(6)
v_lshlrev_b32 v70, 16, v32
v_and_b32 v71, 0xffff0000, v32
v_fmac_f32 v60, v13, v70
v_fmac_f32 v61, v13, v71
v_lshlrev_b32 v70, 16, v33
v_and_b32 v71, 0xffff0000, v33
v_fmac_f32 v62, v13, v70
v_fmac_f32 v63, v13, v71
v_lshlrev_b32 v70, 16, v34
v_and_b32 v71, 0xffff0000, v34
v_fmac_f32 v64, v13, v70
v_fmac_f32 v65, v13, v71
v_lshlrev_b32 v70, 16, v35
v_and_b32 v71, 0xffff0000, v35
v_fmac_f32 v66, v13, v70
v_fmac_f32 v67, v13, v71
s_waitcnt vmcnt(5)
v_lshlrev_b32 v70, 16, v36
v_and_b32 v71, 0xffff0000, v36
v_fmac_f32 v60, v14, v70
v_fmac_f32 v61, v14, v71
v_lshlrev_b32 v70, 16, v37
v_and_b32 v71, 0xffff0000, v37
v_fmac_f32 v62, v14, v70
v_fmac_f32 v63, v14, v71
v_lshlrev_b32 v70, 16, v38
v_and_b32 v71, 0xffff0000, v38
v_fmac_f32 v64, v14, v70
v_fmac_f32 v65, v14, v71
v_lshlrev_b32 v70, 16, v39
v_and_b32 v71, 0xffff0000, v39
v_fmac_f32 v66, v14, v70
v_fmac_f32 v67, v14, v71
s_waitcnt vmcnt(4)
v_lshlrev_b32 v70, 16, v40
v_and_b32 v71, 0xffff0000, v40
v_fmac_f32 v60, v15, v70
v_fmac_f32 v61, v15, v71
v_lshlrev_b32 v70, 16, v41
v_and_b32 v71, 0xffff0000, v41
v_fmac_f32 v62, v15, v70
v_fmac_f32 v63, v15, v71
v_lshlrev_b32 v70, 16, v42
v_and_b32 v71, 0xffff0000, v42
v_fmac_f32 v64, v15, v70
v_fmac_f32 v65, v15, v71
v_lshlrev_b32 v70, 16, v43
v_and_b32 v71, 0xffff0000, v43
v_fmac_f32 v66, v15, v70
v_fmac_f32 v67, v15, v71
s_waitcnt vmcnt(3)
v_lshlrev_b32 v70, 16, v44
v_and_b32 v71, 0xffff0000, v44
v_fmac_f32 v60, v16, v70
v_fmac_f32 v61, v16, v71
v_lshlrev_b32 v70, 16, v45
v_and_b32 v71, 0xffff0000, v45
v_fmac_f32 v62, v16, v70
v_fmac_f32 v63, v16, v71
v_lshlrev_b32 v70, 16, v46
v_and_b32 v71, 0xffff0000, v46
v_fmac_f32 v64, v16, v70
v_fmac_f32 v65, v16, v71
v_lshlrev_b32 v70, 16, v47
v_and_b32 v71, 0xffff0000, v47
v_fmac_f32 v66, v16, v70
v_fmac_f32 v67, v16, v71
s_waitcnt vmcnt(2)
v_lshlrev_b32 v70, 16, v48
v_and_b32 v71, 0xffff0000, v48
v_fmac_f32 v60, v17, v70
v_fmac_f32 v61, v17, v71
v_lshlrev_b32 v70, 16, v49
v_and_b32 v71, 0xffff0000, v49
v_fmac_f32 v62, v17, v70
v_fmac_f32 v63, v17, v71
v_lshlrev_b32 v70, 16, v50
v_and_b32 v71, 0xffff0000, v50
v_fmac_f32 v64, v17, v70
v_fmac_f32 v65, v17, v71
v_lshlrev_b32 v70, 16, v51
v_and_b32 v71, 0xffff0000, v51
v_fmac_f32 v66, v17, v70
v_fmac_f32 v67, v17, v71
s_waitcnt vmcnt(1)
v_lshlrev_b32 v70, 16, v52
v_and_b32 v71, 0xffff0000, v52
v_fmac_f32 v60, v18, v70
v_fmac_f32 v61, v18, v71
v_lshlrev_b32 v70, 16, v53
v_and_b32 v71, 0xffff0000, v53
v_fmac_f32 v62, v18, v70
v_fmac_f32 v63, v18, v71
v_lshlrev_b32 v70, 16, v54
v_and_b32 v71, 0xffff0000, v54
v_fmac_f32 v64, v18, v70
v_fmac_f32 v65, v18, v71
v_lshlrev_b32 v70, 16, v55
v_and_b32 v71, 0xffff0000, v55
v_fmac_f32 v66, v18, v70
v_fmac_f32 v67, v18, v71
s_waitcnt vmcnt(0)
v_lshlrev_b32 v70, 16, v56
v_and_b32 v71, 0xffff0000, v56
v_fmac_f32 v60, v19, v70
v_fmac_f32 v61, v19, v71
v_lshlrev_b32 v70, 16, v57
v_and_b32 v71, 0xffff0000, v57
v_fmac_f32 v62, v19, v70
v_fmac_f32 v63, v19, v71
v_lshlrev_b32 v70, 16, v58
v_and_b32 v71, 0xffff0000, v58
v_fmac_f32 v64, v19, v70
v_fmac_f32 v65, v19, v71
v_lshlrev_b32 v70, 16, v59
v_and_b32 v71, 0xffff0000, v59
v_fmac_f32 v66, v19, v70
v_fmac_f32 v67, v19, v71
s_nop 1
v_add_f32_dpp v60, v60, v60 row_shr:8 row_mask:0xf bank_mask:0xf bound_ctrl:0
v_add_f32_dpp v61, v61, v61 row_shr:8 row_mask:0xf bank_mask:0xf bound_ctrl:0
v_add_f32_dpp v62, v62, v62 row_shr:8 row_mask:0xf bank_mask:0xf bound_ctrl:0
v_add_f32_dpp v63, v63, v63 row_shr:8 row_mask:0xf bank_mask:0xf bound_ctrl:0
v_add_f32_dpp v64, v64, v64 row_shr:8 row_mask:0xf bank_mask:0xf bound_ctrl:0
v_add_f32_dpp v65, v65, v65 row_shr:8 row_mask:0xf bank_mask:0xf bound_ctrl:0
v_add_f32_dpp v66, v66, v66 row_shr:8 row_mask:0xf bank_mask:0xf bound_ctrl:0
v_add_f32_dpp v67, v67, v67 row_shr:8 row_mask:0xf bank_mask:0xf bound_ctrl:0
v_lshrrev_b32 v2, 4, v0
v_lshlrev_b32 v2, 8, v2
v_lshl_add_u32 v2, v1, 5, v2
v_and_b32 v3, 15, v0
v_cmp_le_u32 vcc, 8, v3
s_and_saveexec_b64 s[44:45], vcc
ds_write_b128 v2, v[60:63]
ds_write_b128 v2, v[64:67] offset:16
s_mov_b64 exec, s[44:45]
s_waitcnt lgkmcnt(0)
s_barrier
v_cmp_gt_u32 vcc, 64, v0
s_and_saveexec_b64 s[44:45], vcc
s_cbranch_execz k1_exit
v_lshlrev_b32 v2, 2, v0
ds_read_b32 v10, v2 offset:0
ds_read_b32 v11, v2 offset:256
ds_read_b32 v12, v2 offset:512
ds_read_b32 v13, v2 offset:768
ds_read_b32 v14, v2 offset:1024
ds_read_b32 v15, v2 offset:1280
ds_read_b32 v16, v2 offset:1536
ds_read_b32 v17, v2 offset:1792
ds_read_b32 v18, v2 offset:2048
ds_read_b32 v19, v2 offset:2304
ds_read_b32 v20, v2 offset:2560
ds_read_b32 v21, v2 offset:2816
ds_read_b32 v22, v2 offset:3072
ds_read_b32 v23, v2 offset:3328
ds_read_b32 v24, v2 offset:3584
ds_read_b32 v25, v2 offset:3840
s_lshl_b32 s42, s41, 8
s_mul_i32 s43, s40, 15360
s_add_u32 s42, s42, s43
s_waitcnt lgkmcnt(0)
v_add_f32 v10, v10, v18
v_add_f32 v11, v11, v19
v_add_f32 v12, v12, v20
v_add_f32 v13, v13, v21
v_add_f32 v14, v14, v22
v_add_f32 v15, v15, v23
v_add_f32 v16, v16, v24
v_add_f32 v17, v17, v25
v_add_f32 v10, v10, v14
v_add_f32 v11, v11, v15
v_add_f32 v12, v12, v16
v_add_f32 v13, v13, v17
v_add_f32 v10, v10, v12
v_add_f32 v11, v11, v13
v_add_f32 v10, v10, v11
buffer_store_dword v10, v2, s[24:27], s42 offen sc1
s_endpgm
k1_roleT:
v_lshrrev_b32 v1, 6, v0
s_nop 0
v_readfirstlane_b32 s3, v1
s_load_dwordx2 s[4:5], s[0:1], 0
s_load_dwordx2 s[14:15], s[0:1], 120
s_sub_u32 s40, s2, 760
s_mul_i32 s41, s40, 13108
s_lshr_b32 s41, s41, 16
s_mul_i32 s42, s41, 5
s_sub_u32 s42, s40, s42
v_and_b32 v2, 63, v0
v_lshrrev_b32 v3, 4, v2
v_and_b32 v4, 15, v2
s_and_b32 s43, s3, 1
s_lshl_b32 s43, s43, 3
v_or_b32 v5, s43, v3
v_xor_b32 v5, v5, v4
v_xor_b32 v6, 4, v5
v_mul_u32_u24 v3, 1280, v3
v_lshl_add_u32 v5, v5, 4, v3
v_lshl_add_u32 v6, v6, 4, v3
s_lshl_b32 s43, s41, 6
s_lshl_b32 s44, s3, 4
s_add_u32 s43, s43, s44
s_mul_i32 s43, s43, 1280
s_lshl_b32 s45, s42, 8
s_add_u32 s43, s43, s45
s_lshl_b32 s44, s44, 8
s_waitcnt lgkmcnt(0)
s_mov_b32 s16, s4
s_mov_b32 s17, s5
s_mov_b32 s18, 0x280000
s_mov_b32 s19, 0x20000
s_add_u32 s20, s14, 0x200000
s_addc_u32 s21, s15, 0
s_mov_b32 s22, 0x280000
s_mov_b32 s23, 0x20000
s_mov_b32 m0, s44
s_add_u32 s44, s44, 1024
buffer_load_dwordx4 v5, s[16:19], s43 offen lds
s_add_u32 s43, s43, 5120
s_mov_b32 m0, s44
s_add_u32 s44, s44, 1024
buffer_load_dwordx4 v5, s[16:19], s43 offen lds
s_add_u32 s43, s43, 5120
s_mov_b32 m0, s44
s_add_u32 s44, s44, 1024
buffer_load_dwordx4 v6, s[16:19], s43 offen lds
s_add_u32 s43, s43, 5120
s_mov_b32 m0, s44
s_add_u32 s44, s44, 1024
buffer_load_dwordx4 v6, s[16:19], s43 offen lds
s_add_u32 s43, s43, 5120
v_lshrrev_b32 v3, 4, v2
v_bfe_u32 v4, v2, 2, 2
v_bfe_u32 v5, v2, 1, 1
v_and_b32 v6, 1, v2
v_lshl_add_u32 v7, v5, 3, v4
v_lshl_add_u32 v7, v3, 4, v7
v_lshl_add_u32 v8, v5, 2, v4
v_and_b32 v9, 1, v3
v_lshl_add_u32 v8, v9, 3, v8
s_lshl_b32 s45, s3, 2
v_xor_b32 v8, s45, v8
v_lshlrev_b32 v8, 4, v8
v_lshl_add_u32 v8, v7, 8, v8
v_lshl_add_u32 v8, v6, 3, v8
v_xor_b32 v9, 16, v8
v_xor_b32 v10, 32, v8
v_xor_b32 v11, 48, v8
v_and_b32 v4, 7, v2
v_lshlrev_b32 v4, 12, v4
v_bfe_u32 v5, v2, 3, 1
v_lshl_add_u32 v5, v3, 1, v5
v_lshl_add_u32 v4, v5, 4, v4
s_lshl_b32 s45, s42, 7
s_lshl_b32 s46, s3, 5
s_add_u32 s45, s45, s46
s_lshl_b32 s45, s45, 12
s_lshl_b32 s46, s41, 7
s_add_u32 s45, s45, s46
s_waitcnt vmcnt(0)
s_barrier
ds_read_b64_tr_b16 v[12:13], v8
ds_read_b64_tr_b16 v[14:15], v8 offset:1024
ds_read_b64_tr_b16 v[16:17], v9
ds_read_b64_tr_b16 v[18:19], v9 offset:1024
ds_read_b64_tr_b16 v[20:21], v10
ds_read_b64_tr_b16 v[22:23], v10 offset:1024
ds_read_b64_tr_b16 v[24:25], v11
ds_read_b64_tr_b16 v[26:27], v11 offset:1024
s_waitcnt lgkmcnt(6)
buffer_store_dwordx4 v[12:15], v4, s[20:23], s45 offen sc1
s_add_u32 s45, s45, 32768
s_waitcnt lgkmcnt(4)
buffer_store_dwordx4 v[16:19], v4, s[20:23], s45 offen sc1
s_add_u32 s45, s45, 32768
s_waitcnt lgkmcnt(2)
buffer_store_dwordx4 v[20:23], v4, s[20:23], s45 offen sc1
s_add_u32 s45, s45, 32768
s_waitcnt lgkmcnt(0)
buffer_store_dwordx4 v[24:27], v4, s[20:23], s45 offen sc1
s_waitcnt vmcnt(0)
s_endpgm
k1_roleS:
s_load_dwordx2 s[4:5], s[0:1], 0
s_load_dwordx2 s[14:15], s[0:1], 120
s_sub_u32 s40, s2, 920
s_lshl_b32 s40, s40, 4
v_lshrrev_b32 v1, 4, v0
v_add_u32 v1, s40, v1
v_and_b32 v2, 15, v0
v_mul_u32_u24 v3, 1280, v1
v_lshl_add_u32 v3, v2, 4, v3
s_waitcnt lgkmcnt(0)
s_mov_b32 s16, s4
s_mov_b32 s17, s5
s_mov_b32 s18, 0x280000
s_mov_b32 s19, 0x20000
s_add_u32 s20, s14, 0x4000
s_addc_u32 s21, s15, 0
s_mov_b32 s22, 0x4000
s_mov_b32 s23, 0x20000
buffer_load_dwordx4 v[4:7], v3, s[16:19], 0 offen offset:0
buffer_load_dwordx4 v[8:11], v3, s[16:19], 0 offen offset:256
buffer_load_dwordx4 v[12:15], v3, s[16:19], 0 offen offset:512
buffer_load_dwordx4 v[16:19], v3, s[16:19], 0 offen offset:768
buffer_load_dwordx4 v[20:23], v3, s[16:19], 0 offen offset:1024
s_waitcnt vmcnt(4)
v_lshlrev_b32 v24, 16, v4
v_and_b32 v25, 0xffff0000, v4
v_lshlrev_b32 v26, 16, v5
v_and_b32 v27, 0xffff0000, v5
v_lshlrev_b32 v28, 16, v6
v_and_b32 v29, 0xffff0000, v6
v_lshlrev_b32 v30, 16, v7
v_and_b32 v31, 0xffff0000, v7
s_waitcnt vmcnt(3)
v_lshlrev_b32 v32, 16, v8
v_and_b32 v33, 0xffff0000, v8
v_lshlrev_b32 v34, 16, v9
v_and_b32 v35, 0xffff0000, v9
v_lshlrev_b32 v36, 16, v10
v_and_b32 v37, 0xffff0000, v10
v_lshlrev_b32 v38, 16, v11
v_and_b32 v39, 0xffff0000, v11
s_waitcnt vmcnt(2)
v_lshlrev_b32 v40, 16, v12
v_and_b32 v41, 0xffff0000, v12
v_lshlrev_b32 v42, 16, v13
v_and_b32 v43, 0xffff0000, v13
v_lshlrev_b32 v44, 16, v14
v_and_b32 v45, 0xffff0000, v14
v_lshlrev_b32 v46, 16, v15
v_and_b32 v47, 0xffff0000, v15
s_waitcnt vmcnt(1)
v_lshlrev_b32 v48, 16, v16
v_and_b32 v49, 0xffff0000, v16
v_lshlrev_b32 v50, 16, v17
v_and_b32 v51, 0xffff0000, v17
v_lshlrev_b32 v52, 16, v18
v_and_b32 v53, 0xffff0000, v18
v_lshlrev_b32 v54, 16, v19
v_and_b32 v55, 0xffff0000, v19
s_waitcnt vmcnt(0)
v_lshlrev_b32 v56, 16, v20
v_and_b32 v57, 0xffff0000, v20
v_lshlrev_b32 v58, 16, v21
v_and_b32 v59, 0xffff0000, v21
v_lshlrev_b32 v60, 16, v22
v_and_b32 v61, 0xffff0000, v22
v_lshlrev_b32 v62, 16, v23
v_and_b32 v63, 0xffff0000, v23
v_add_f32 v4, v24, v28
v_add_f32 v5, v25, v29
v_add_f32 v6, v26, v30
v_add_f32 v7, v27, v31
v_add_f32 v4, v4, v32
v_add_f32 v5, v5, v33
v_add_f32 v6, v6, v34
v_add_f32 v7, v7, v35
v_add_f32 v4, v4, v36
v_add_f32 v5, v5, v37
v_add_f32 v6, v6, v38
v_add_f32 v7, v7, v39
v_add_f32 v4, v4, v40
v_add_f32 v5, v5, v41
v_add_f32 v6, v6, v42
v_add_f32 v7, v7, v43
v_add_f32 v4, v4, v44
v_add_f32 v5, v5, v45
v_add_f32 v6, v6, v46
v_add_f32 v7, v7, v47
v_add_f32 v4, v4, v48
v_add_f32 v5, v5, v49
v_add_f32 v6, v6, v50
v_add_f32 v7, v7, v51
v_add_f32 v4, v4, v52
v_add_f32 v5, v5, v53
v_add_f32 v6, v6, v54
v_add_f32 v7, v7, v55
v_add_f32 v4, v4, v56
v_add_f32 v5, v5, v57
v_add_f32 v6, v6, v58
v_add_f32 v7, v7, v59
v_add_f32 v4, v4, v60
v_add_f32 v5, v5, v61
v_add_f32 v6, v6, v62
v_add_f32 v7, v7, v63
v_add_f32 v4, v4, v5
v_add_f32 v6, v6, v7
v_add_f32 v4, v4, v6
s_nop 1
v_add_f32_dpp v4, v4, v4 row_ror:8 row_mask:0xf bank_mask:0xf
s_nop 1
v_add_f32_dpp v4, v4, v4 row_ror:4 row_mask:0xf bank_mask:0xf
s_nop 1
v_add_f32_dpp v4, v4, v4 row_ror:2 row_mask:0xf bank_mask:0xf
s_nop 1
v_add_f32_dpp v4, v4, v4 row_ror:1 row_mask:0xf bank_mask:0xf
v_mul_f32 v4, 0x3acccccd, v4
v_sub_f32 v24, v24, v4
v_sub_f32 v25, v25, v4
v_sub_f32 v26, v26, v4
v_sub_f32 v27, v27, v4
v_sub_f32 v28, v28, v4
v_sub_f32 v29, v29, v4
v_sub_f32 v30, v30, v4
v_sub_f32 v31, v31, v4
v_sub_f32 v32, v32, v4
v_sub_f32 v33, v33, v4
v_sub_f32 v34, v34, v4
v_sub_f32 v35, v35, v4
v_sub_f32 v36, v36, v4
v_sub_f32 v37, v37, v4
v_sub_f32 v38, v38, v4
v_sub_f32 v39, v39, v4
v_sub_f32 v40, v40, v4
v_sub_f32 v41, v41, v4
v_sub_f32 v42, v42, v4
v_sub_f32 v43, v43, v4
v_sub_f32 v44, v44, v4
v_sub_f32 v45, v45, v4
v_sub_f32 v46, v46, v4
v_sub_f32 v47, v47, v4
v_sub_f32 v48, v48, v4
v_sub_f32 v49, v49, v4
v_sub_f32 v50, v50, v4
v_sub_f32 v51, v51, v4
v_sub_f32 v52, v52, v4
v_sub_f32 v53, v53, v4
v_sub_f32 v54, v54, v4
v_sub_f32 v55, v55, v4
v_sub_f32 v56, v56, v4
v_sub_f32 v57, v57, v4
v_sub_f32 v58, v58, v4
v_sub_f32 v59, v59, v4
v_sub_f32 v60, v60, v4
v_sub_f32 v61, v61, v4
v_sub_f32 v62, v62, v4
v_sub_f32 v63, v63, v4
v_mul_f32 v8, v24, v24
v_mul_f32 v9, v25, v25
v_mul_f32 v10, v26, v26
v_mul_f32 v11, v27, v27
v_fmac_f32 v8, v28, v28
v_fmac_f32 v9, v29, v29
v_fmac_f32 v10, v30, v30
v_fmac_f32 v11, v31, v31
v_fmac_f32 v8, v32, v32
v_fmac_f32 v9, v33, v33
v_fmac_f32 v10, v34, v34
v_fmac_f32 v11, v35, v35
v_fmac_f32 v8, v36, v36
v_fmac_f32 v9, v37, v37
v_fmac_f32 v10, v38, v38
v_fmac_f32 v11, v39, v39
v_fmac_f32 v8, v40, v40
v_fmac_f32 v9, v41, v41
v_fmac_f32 v10, v42, v42
v_fmac_f32 v11, v43, v43
v_fmac_f32 v8, v44, v44
v_fmac_f32 v9, v45, v45
v_fmac_f32 v10, v46, v46
v_fmac_f32 v11, v47, v47
v_fmac_f32 v8, v48, v48
v_fmac_f32 v9, v49, v49
v_fmac_f32 v10, v50, v50
v_fmac_f32 v11, v51, v51
v_fmac_f32 v8, v52, v52
v_fmac_f32 v9, v53, v53
v_fmac_f32 v10, v54, v54
v_fmac_f32 v11, v55, v55
v_fmac_f32 v8, v56, v56
v_fmac_f32 v9, v57, v57
v_fmac_f32 v10, v58, v58
v_fmac_f32 v11, v59, v59
v_fmac_f32 v8, v60, v60
v_fmac_f32 v9, v61, v61
v_fmac_f32 v10, v62, v62
v_fmac_f32 v11, v63, v63
v_add_f32 v8, v8, v9
v_add_f32 v10, v10, v11
v_add_f32 v8, v8, v10
s_nop 1
v_add_f32_dpp v8, v8, v8 row_ror:8 row_mask:0xf bank_mask:0xf
s_nop 1
v_add_f32_dpp v8, v8, v8 row_ror:4 row_mask:0xf bank_mask:0xf
s_nop 1
v_add_f32_dpp v8, v8, v8 row_ror:2 row_mask:0xf bank_mask:0xf
s_nop 1
v_add_f32_dpp v8, v8, v8 row_ror:1 row_mask:0xf bank_mask:0xf
v_mov_b32 v9, 0x3727c5ac
v_fmac_f32 v9, 0x3acccccd, v8
v_rsq_f32 v8, v9
v_lshlrev_b32 v3, 2, v1
v_mul_f32 v9, v8, v4
v_sub_f32 v9, 0, v9
v_cmp_eq_u32 vcc, 0, v2
s_and_saveexec_b64 s[44:45], vcc
s_cbranch_execz k1_exit
s_movk_i32 s46, 8192
buffer_store_dword v8, v3, s[20:23], 0 offen sc1
buffer_store_dword v9, v3, s[20:23], s46 offen sc1
s_waitcnt vmcnt(0)
s_endpgm
k1_roleK:
v_lshrrev_b32 v1, 6, v0
s_nop 0
v_readfirstlane_b32 s3, v1
s_load_dwordx4 s[4:7], s[0:1], 8
s_load_dwordx4 s[8:11], s[0:1], 24
s_load_dwordx2 s[12:13], s[0:1], 40
s_load_dwordx2 s[14:15], s[0:1], 120
s_sub_u32 s61, s2, 0
s_cmp_eq_u32 s3, 3
s_cbranch_scc1 k1_kfin0
s_mul_i32 s40, s61, 192
v_add_u32 v1, s40, v0
v_lshlrev_b32 v1, 1, v1
s_lshl_b32 s41, s61, 1
v_mov_b32 v2, s41
s_waitcnt lgkmcnt(0)
global_load_ushort v3, v2, s[12:13]
global_load_ushort v4, v1, s[4:5]
global_load_ushort v5, v1, s[6:7]
global_load_ushort v10, v1, s[8:9]
global_load_ushort v11, v1, s[10:11]
s_getpc_b64 s[68:69]
k1_pc2:
s_add_u32 s68, s68, k1_tab_w-k1_pc2
s_addc_u32 s69, s69, 0
v_and_b32 v6, 63, v0
v_lshlrev_b32 v6, 4, v6
global_load_dwordx4 v[44:47], v6, s[68:69]
s_mul_i32 s42, s3, 9216
v_and_b32 v6, 63, v0
v_and_b32 v7, 15, v6
v_lshrrev_b32 v8, 4, v6
v_mul_u32_u24 v9, 288, v7
v_lshl_add_u32 v9, v8, 4, v9
s_waitcnt vmcnt(0)
v_add_u32 v2, s42, v9
s_mov_b32 m0, s42
s_nop 0
v_lshlrev_b32 v3, 16, v3
v_lshlrev_b32 v4, 16, v4
v_lshlrev_b32 v5, 16, v5
v_lshlrev_b32 v10, 16, v10
v_lshlrev_b32 v11, 16, v11
v_mul_f32 v3, 0x3fb8aa3b, v3
v_mul_f32 v4, 0x3fb8aa3b, v4
v_exp_f32 v3, v3
v_exp_f32 v4, v4
s_nop 0
v_cvt_pk_bf16_f32 v6, v3, v3
v_lshlrev_b32 v3, 16, v6
v_cvt_pk_bf16_f32 v6, v4, v4
v_lshlrev_b32 v4, 16, v6
v_mul_f32 v4, v4, v3
v_mul_f32 v5, v5, v3
v_mul_f32 v4, 0xbfb8aa3b, v4
v_mul_f32 v5, 0x3e22f983, v5
v_mul_f32 v6, 0x41000000, v4
v_mul_f32 v7, 0x41000000, v5
v_exp_f32 v6, v6
v_fract_f32 v7, v7
v_cos_f32 v12, v7
v_sin_f32 v13, v7
s_nop 0
v_mul_f32 v12, v12, v6
v_mul_f32 v13, v13, v6
v_pk_mul_f32 v[14:15], v[12:13], v[12:13] op_sel:[0,0] op_sel_hi:[1,0]
v_pk_fma_f32 v[14:15], v[12:13], v[12:13], v[14:15] op_sel:[1,1,0] op_sel_hi:[0,1,1] neg_lo:[1,0,0]
v_pk_mul_f32 v[16:17], v[14:15], v[12:13] op_sel:[0,0] op_sel_hi:[1,0]
v_pk_fma_f32 v[16:17], v[14:15], v[12:13], v[16:17] op_sel:[1,1,0] op_sel_hi:[0,1,1] neg_lo:[1,0,0]
v_pk_mul_f32 v[18:19], v[14:15], v[14:15] op_sel:[0,0] op_sel_hi:[1,0]
v_pk_fma_f32 v[18:19], v[14:15], v[14:15], v[18:19] op_sel:[1,1,0] op_sel_hi:[0,1,1] neg_lo:[1,0,0]
v_pk_mul_f32 v[20:21], v[18:19], v[18:19] op_sel:[0,0] op_sel_hi:[1,0]
v_pk_fma_f32 v[20:21], v[18:19], v[18:19], v[20:21] op_sel:[1,1,0] op_sel_hi:[0,1,1] neg_lo:[1,0,0]
v_pk_mul_f32 v[22:23], v[20:21], v[18:19] op_sel:[0,0] op_sel_hi:[1,0]
v_pk_fma_f32 v[22:23], v[20:21], v[18:19], v[22:23] op_sel:[1,1,0] op_sel_hi:[0,1,1] neg_lo:[1,0,0]
v_cvt_pk_f16_f32 v25, v12, v13
v_cvt_pk_f16_f32 v26, v14, v15
v_cvt_pk_f16_f32 v27, v16, v17
v_cvt_pk_f16_f32 v28, v18, v19
v_cvt_pk_f16_f32 v29, v20, v21
v_cvt_pk_f16_f32 v30, v22, v23
v_mov_b32 v24, 0x3c00
ds_write_addtid_b32 v24 offset:0
ds_write_addtid_b32 v25 offset:288
ds_write_addtid_b32 v26 offset:576
ds_write_addtid_b32 v27 offset:864
ds_write_addtid_b32 v28 offset:1152
v_pk_mul_f16 v32, v28, v25 op_sel:[0,0] op_sel_hi:[1,0]
v_pk_fma_f16 v32, v28, v25, v32 op_sel:[1,1,0] op_sel_hi:[0,1,1] neg_lo:[1,0,0]
ds_write_addtid_b32 v32 offset:1440
v_pk_mul_f16 v33, v28, v26 op_sel:[0,0] op_sel_hi:[1,0]
v_pk_fma_f16 v33, v28, v26, v33 op_sel:[1,1,0] op_sel_hi:[0,1,1] neg_lo:[1,0,0]
ds_write_addtid_b32 v33 offset:1728
v_pk_mul_f16 v34, v28, v27 op_sel:[0,0] op_sel_hi:[1,0]
v_pk_fma_f16 v34, v28, v27, v34 op_sel:[1,1,0] op_sel_hi:[0,1,1] neg_lo:[1,0,0]
ds_write_addtid_b32 v34 offset:2016
ds_write_addtid_b32 v29 offset:2304
v_pk_mul_f16 v35, v29, v25 op_sel:[0,0] op_sel_hi:[1,0]
v_pk_fma_f16 v35, v29, v25, v35 op_sel:[1,1,0] op_sel_hi:[0,1,1] neg_lo:[1,0,0]
ds_write_addtid_b32 v35 offset:2592
v_pk_mul_f16 v32, v29, v26 op_sel:[0,0] op_sel_hi:[1,0]
v_pk_fma_f16 v32, v29, v26, v32 op_sel:[1,1,0] op_sel_hi:[0,1,1] neg_lo:[1,0,0]
ds_write_addtid_b32 v32 offset:2880
v_pk_mul_f16 v33, v29, v27 op_sel:[0,0] op_sel_hi:[1,0]
v_pk_fma_f16 v33, v29, v27, v33 op_sel:[1,1,0] op_sel_hi:[0,1,1] neg_lo:[1,0,0]
ds_write_addtid_b32 v33 offset:3168
ds_write_addtid_b32 v30 offset:3456
v_pk_mul_f16 v34, v30, v25 op_sel:[0,0] op_sel_hi:[1,0]
v_pk_fma_f16 v34, v30, v25, v34 op_sel:[1,1,0] op_sel_hi:[0,1,1] neg_lo:[1,0,0]
ds_write_addtid_b32 v34 offset:3744
v_pk_mul_f16 v35, v30, v26 op_sel:[0,0] op_sel_hi:[1,0]
v_pk_fma_f16 v35, v30, v26, v35 op_sel:[1,1,0] op_sel_hi:[0,1,1] neg_lo:[1,0,0]
ds_write_addtid_b32 v35 offset:4032
v_pk_mul_f16 v32, v30, v27 op_sel:[0,0] op_sel_hi:[1,0]
v_pk_fma_f16 v32, v30, v27, v32 op_sel:[1,1,0] op_sel_hi:[0,1,1] neg_lo:[1,0,0]
ds_write_addtid_b32 v32 offset:4320
ds_read_b128 v[48:51], v2 offset:0
ds_read_b128 v[52:55], v2 offset:64
ds_read_b128 v[56:59], v2 offset:128
ds_read_b128 v[60:63], v2 offset:192
v_exp_f32 v6, v4
v_fract_f32 v7, v5
v_cos_f32 v8, v7
v_sin_f32 v9, v7
s_nop 0
v_mul_f32 v8, v8, v6
v_mul_f32 v9, v9, v6
v_cvt_pk_f16_f32 v14, v10, -v11
ds_write_addtid_b32 v14 offset:4608
v_pk_mul_f32 v[12:13], v[10:11], v[8:9] op_sel:[0,0] op_sel_hi:[1,0]
v_pk_fma_f32 v[12:13], v[10:11], v[8:9], v[12:13] op_sel:[1,1,0] op_sel_hi:[0,1,1] neg_lo:[1,0,0]
v_cvt_pk_f16_f32 v15, v12, -v13
ds_write_addtid_b32 v15 offset:4896
v_pk_mul_f32 v[10:11], v[12:13], v[8:9] op_sel:[0,0] op_sel_hi:[1,0]
v_pk_fma_f32 v[10:11], v[12:13], v[8:9], v[10:11] op_sel:[1,1,0] op_sel_hi:[0,1,1] neg_lo:[1,0,0]
v_cvt_pk_f16_f32 v16, v10, -v11
ds_write_addtid_b32 v16 offset:5184
v_pk_mul_f32 v[12:13], v[10:11], v[8:9] op_sel:[0,0] op_sel_hi:[1,0]
v_pk_fma_f32 v[12:13], v[10:11], v[8:9], v[12:13] op_sel:[1,1,0] op_sel_hi:[0,1,1] neg_lo:[1,0,0]
v_cvt_pk_f16_f32 v17, v12, -v13
ds_write_addtid_b32 v17 offset:5472
v_pk_mul_f32 v[10:11], v[12:13], v[8:9] op_sel:[0,0] op_sel_hi:[1,0]
v_pk_fma_f32 v[10:11], v[12:13], v[8:9], v[10:11] op_sel:[1,1,0] op_sel_hi:[0,1,1] neg_lo:[1,0,0]
v_cvt_pk_f16_f32 v18, v10, -v11
ds_write_addtid_b32 v18 offset:5760
v_pk_mul_f32 v[12:13], v[10:11], v[8:9] op_sel:[0,0] op_sel_hi:[1,0]
v_pk_fma_f32 v[12:13], v[10:11], v[8:9], v[12:13] op_sel:[1,1,0] op_sel_hi:[0,1,1] neg_lo:[1,0,0]
v_cvt_pk_f16_f32 v19, v12, -v13
ds_write_addtid_b32 v19 offset:6048
v_pk_mul_f32 v[10:11], v[12:13], v[8:9] op_sel:[0,0] op_sel_hi:[1,0]
v_pk_fma_f32 v[10:11], v[12:13], v[8:9], v[10:11] op_sel:[1,1,0] op_sel_hi:[0,1,1] neg_lo:[1,0,0]
v_cvt_pk_f16_f32 v20, v10, -v11
ds_write_addtid_b32 v20 offset:6336
v_pk_mul_f32 v[12:13], v[10:11], v[8:9] op_sel:[0,0] op_sel_hi:[1,0]
v_pk_fma_f32 v[12:13], v[10:11], v[8:9], v[12:13] op_sel:[1,1,0] op_sel_hi:[0,1,1] neg_lo:[1,0,0]
v_cvt_pk_f16_f32 v21, v12, -v13
ds_write_addtid_b32 v21 offset:6624
v_mul_f32 v6, 0x43000000, v4
v_mul_f32 v7, 0x43000000, v5
v_exp_f32 v6, v6
v_fract_f32 v7, v7
v_cos_f32 v8, v7
v_sin_f32 v9, v7
s_nop 0
v_mul_f32 v8, v8, v6
v_mul_f32 v9, v9, v6
v_cvt_pk_f16_f32 v30, v8, v9
v_pk_mul_f16 v22, v14, v30 op_sel:[0,0] op_sel_hi:[1,0]
v_pk_fma_f16 v22, v14, v30, v22 op_sel:[1,1,0] op_sel_hi:[0,1,1] neg_hi:[1,0,0]
ds_write_addtid_b32 v22 offset:6912
v_pk_mul_f16 v23, v15, v30 op_sel:[0,0] op_sel_hi:[1,0]
v_pk_fma_f16 v23, v15, v30, v23 op_sel:[1,1,0] op_sel_hi:[0,1,1] neg_hi:[1,0,0]
ds_write_addtid_b32 v23 offset:7200
v_pk_mul_f16 v24, v16, v30 op_sel:[0,0] op_sel_hi:[1,0]
v_pk_fma_f16 v24, v16, v30, v24 op_sel:[1,1,0] op_sel_hi:[0,1,1] neg_hi:[1,0,0]
ds_write_addtid_b32 v24 offset:7488
v_pk_mul_f16 v25, v17, v30 op_sel:[0,0] op_sel_hi:[1,0]
v_pk_fma_f16 v25, v17, v30, v25 op_sel:[1,1,0] op_sel_hi:[0,1,1] neg_hi:[1,0,0]
ds_write_addtid_b32 v25 offset:7776
v_pk_mul_f16 v26, v18, v30 op_sel:[0,0] op_sel_hi:[1,0]
v_pk_fma_f16 v26, v18, v30, v26 op_sel:[1,1,0] op_sel_hi:[0,1,1] neg_hi:[1,0,0]
ds_write_addtid_b32 v26 offset:8064
v_pk_mul_f16 v27, v19, v30 op_sel:[0,0] op_sel_hi:[1,0]
v_pk_fma_f16 v27, v19, v30, v27 op_sel:[1,1,0] op_sel_hi:[0,1,1] neg_hi:[1,0,0]
ds_write_addtid_b32 v27 offset:8352
v_pk_mul_f16 v28, v20, v30 op_sel:[0,0] op_sel_hi:[1,0]
v_pk_fma_f16 v28, v20, v30, v28 op_sel:[1,1,0] op_sel_hi:[0,1,1] neg_hi:[1,0,0]
ds_write_addtid_b32 v28 offset:8640
v_pk_mul_f16 v29, v21, v30 op_sel:[0,0] op_sel_hi:[1,0]
v_pk_fma_f16 v29, v21, v30, v29 op_sel:[1,1,0] op_sel_hi:[0,1,1] neg_hi:[1,0,0]
ds_write_addtid_b32 v29 offset:8928
ds_read_b128 v[64:67], v2 offset:4608
ds_read_b128 v[68:71], v2 offset:4672
ds_read_b128 v[72:75], v2 offset:4736
ds_read_b128 v[76:79], v2 offset:4800
v_mul_f32 v6, 0x43800000, v4
v_mul_f32 v7, 0x43800000, v5
v_exp_f32 v6, v6
v_fract_f32 v7, v7
v_cos_f32 v8, v7
v_sin_f32 v9, v7
s_nop 0
v_mul_f32 v8, v8, v6
v_mul_f32 v9, v9, v6
v_cvt_pk_f16_f32 v30, v8, v9
s_waitcnt lgkmcnt(0)
v_mfma_f32_16x16x32_f16 v[80:83], v[64:67], v[48:51], 0
v_mfma_f32_16x16x32_f16 v[80:83], v[68:71], v[52:55], v[80:83]
v_mfma_f32_16x16x32_f16 v[80:83], v[72:75], v[56:59], v[80:83]
v_mfma_f32_16x16x32_f16 v[80:83], v[76:79], v[60:63], v[80:83]
v_pk_mul_f16 v32, v14, v30 op_sel:[0,0] op_sel_hi:[1,0]
v_pk_fma_f16 v32, v14, v30, v32 op_sel:[1,1,0] op_sel_hi:[0,1,1] neg_hi:[1,0,0]
ds_write_addtid_b32 v32 offset:4608
v_pk_mul_f16 v42, v16, v30 op_sel:[0,0] op_sel_hi:[1,0]
v_pk_fma_f16 v42, v16, v30, v42 op_sel:[1,1,0] op_sel_hi:[0,1,1] neg_hi:[1,0,0]
ds_write_addtid_b32 v42 offset:4896
v_pk_mul_f16 v33, v18, v30 op_sel:[0,0] op_sel_hi:[1,0]
v_pk_fma_f16 v33, v18, v30, v33 op_sel:[1,1,0] op_sel_hi:[0,1,1] neg_hi:[1,0,0]
ds_write_addtid_b32 v33 offset:5184
v_pk_mul_f16 v42, v20, v30 op_sel:[0,0] op_sel_hi:[1,0]
v_pk_fma_f16 v42, v20, v30, v42 op_sel:[1,1,0] op_sel_hi:[0,1,1] neg_hi:[1,0,0]
ds_write_addtid_b32 v42 offset:5472
v_pk_mul_f16 v34, v22, v30 op_sel:[0,0] op_sel_hi:[1,0]
v_pk_fma_f16 v34, v22, v30, v34 op_sel:[1,1,0] op_sel_hi:[0,1,1] neg_hi:[1,0,0]
ds_write_addtid_b32 v34 offset:5760
v_pk_mul_f16 v42, v24, v30 op_sel:[0,0] op_sel_hi:[1,0]
v_pk_fma_f16 v42, v24, v30, v42 op_sel:[1,1,0] op_sel_hi:[0,1,1] neg_hi:[1,0,0]
ds_write_addtid_b32 v42 offset:6048
v_pk_mul_f16 v35, v26, v30 op_sel:[0,0] op_sel_hi:[1,0]
v_pk_fma_f16 v35, v26, v30, v35 op_sel:[1,1,0] op_sel_hi:[0,1,1] neg_hi:[1,0,0]
ds_write_addtid_b32 v35 offset:6336
v_pk_mul_f16 v42, v28, v30 op_sel:[0,0] op_sel_hi:[1,0]
v_pk_fma_f16 v42, v28, v30, v42 op_sel:[1,1,0] op_sel_hi:[0,1,1] neg_hi:[1,0,0]
ds_write_addtid_b32 v42 offset:6624
v_mul_f32 v6, 0x44000000, v4
v_mul_f32 v7, 0x44000000, v5
v_exp_f32 v6, v6
v_fract_f32 v7, v7
v_cos_f32 v8, v7
v_sin_f32 v9, v7
s_nop 0
v_mul_f32 v8, v8, v6
v_mul_f32 v9, v9, v6
v_cvt_pk_f16_f32 v30, v8, v9
v_pk_mul_f16 v36, v14, v30 op_sel:[0,0] op_sel_hi:[1,0]
v_pk_fma_f16 v36, v14, v30, v36 op_sel:[1,1,0] op_sel_hi:[0,1,1] neg_hi:[1,0,0]
ds_write_addtid_b32 v36 offset:6912
v_pk_mul_f16 v42, v18, v30 op_sel:[0,0] op_sel_hi:[1,0]
v_pk_fma_f16 v42, v18, v30, v42 op_sel:[1,1,0] op_sel_hi:[0,1,1] neg_hi:[1,0,0]
ds_write_addtid_b32 v42 offset:7200
v_pk_mul_f16 v37, v22, v30 op_sel:[0,0] op_sel_hi:[1,0]
v_pk_fma_f16 v37, v22, v30, v37 op_sel:[1,1,0] op_sel_hi:[0,1,1] neg_hi:[1,0,0]
ds_write_addtid_b32 v37 offset:7488
v_pk_mul_f16 v42, v26, v30 op_sel:[0,0] op_sel_hi:[1,0]
v_pk_fma_f16 v42, v26, v30, v42 op_sel:[1,1,0] op_sel_hi:[0,1,1] neg_hi:[1,0,0]
ds_write_addtid_b32 v42 offset:7776
v_pk_mul_f16 v38, v32, v30 op_sel:[0,0] op_sel_hi:[1,0]
v_pk_fma_f16 v38, v32, v30, v38 op_sel:[1,1,0] op_sel_hi:[0,1,1] neg_hi:[1,0,0]
ds_write_addtid_b32 v38 offset:8064
v_pk_mul_f16 v42, v33, v30 op_sel:[0,0] op_sel_hi:[1,0]
v_pk_fma_f16 v42, v33, v30, v42 op_sel:[1,1,0] op_sel_hi:[0,1,1] neg_hi:[1,0,0]
ds_write_addtid_b32 v42 offset:8352
v_pk_mul_f16 v39, v34, v30 op_sel:[0,0] op_sel_hi:[1,0]
v_pk_fma_f16 v39, v34, v30, v39 op_sel:[1,1,0] op_sel_hi:[0,1,1] neg_hi:[1,0,0]
ds_write_addtid_b32 v39 offset:8640
v_pk_mul_f16 v42, v35, v30 op_sel:[0,0] op_sel_hi:[1,0]
v_pk_fma_f16 v42, v35, v30, v42 op_sel:[1,1,0] op_sel_hi:[0,1,1] neg_hi:[1,0,0]
ds_write_addtid_b32 v42 offset:8928
ds_read_b128 v[64:67], v2 offset:4608
ds_read_b128 v[68:71], v2 offset:4672
ds_read_b128 v[72:75], v2 offset:4736
ds_read_b128 v[76:79], v2 offset:4800
v_mul_f32 v6, 0x44800000, v4
v_mul_f32 v7, 0x44800000, v5
v_exp_f32 v6, v6
v_fract_f32 v7, v7
v_cos_f32 v8, v7
v_sin_f32 v9, v7
s_nop 0
v_mul_f32 v8, v8, v6
v_mul_f32 v9, v9, v6
v_cvt_pk_f16_f32 v30, v8, v9
s_waitcnt lgkmcnt(0)
v_mfma_f32_16x16x32_f16 v[84:87], v[64:67], v[48:51], 0
v_mfma_f32_16x16x32_f16 v[84:87], v[68:71], v[52:55], v[84:87]
v_mfma_f32_16x16x32_f16 v[84:87], v[72:75], v[56:59], v[84:87]
v_mfma_f32_16x16x32_f16 v[84:87], v[76:79], v[60:63], v[84:87]
v_pk_mul_f16 v40, v14, v30 op_sel:[0,0] op_sel_hi:[1,0]
v_pk_fma_f16 v40, v14, v30, v40 op_sel:[1,1,0] op_sel_hi:[0,1,1] neg_hi:[1,0,0]
ds_write_addtid_b32 v40 offset:4608
v_pk_mul_f16 v42, v22, v30 op_sel:[0,0] op_sel_hi:[1,0]
v_pk_fma_f16 v42, v22, v30, v42 op_sel:[1,1,0] op_sel_hi:[0,1,1] neg_hi:[1,0,0]
ds_write_addtid_b32 v42 offset:4896
v_pk_mul_f16 v41, v32, v30 op_sel:[0,0] op_sel_hi:[1,0]
v_pk_fma_f16 v41, v32, v30, v41 op_sel:[1,1,0] op_sel_hi:[0,1,1] neg_hi:[1,0,0]
ds_write_addtid_b32 v41 offset:5184
v_pk_mul_f16 v42, v34, v30 op_sel:[0,0] op_sel_hi:[1,0]
v_pk_fma_f16 v42, v34, v30, v42 op_sel:[1,1,0] op_sel_hi:[0,1,1] neg_hi:[1,0,0]
ds_write_addtid_b32 v42 offset:5472
v_pk_mul_f16 v41, v36, v30 op_sel:[0,0] op_sel_hi:[1,0]
v_pk_fma_f16 v41, v36, v30, v41 op_sel:[1,1,0] op_sel_hi:[0,1,1] neg_hi:[1,0,0]
ds_write_addtid_b32 v41 offset:5760
v_pk_mul_f16 v42, v37, v30 op_sel:[0,0] op_sel_hi:[1,0]
v_pk_fma_f16 v42, v37, v30, v42 op_sel:[1,1,0] op_sel_hi:[0,1,1] neg_hi:[1,0,0]
ds_write_addtid_b32 v42 offset:6048
v_pk_mul_f16 v41, v38, v30 op_sel:[0,0] op_sel_hi:[1,0]
v_pk_fma_f16 v41, v38, v30, v41 op_sel:[1,1,0] op_sel_hi:[0,1,1] neg_hi:[1,0,0]
ds_write_addtid_b32 v41 offset:6336
v_pk_mul_f16 v42, v39, v30 op_sel:[0,0] op_sel_hi:[1,0]
v_pk_fma_f16 v42, v39, v30, v42 op_sel:[1,1,0] op_sel_hi:[0,1,1] neg_hi:[1,0,0]
ds_write_addtid_b32 v42 offset:6624
v_pk_mul_f16 v41, v40, v30 op_sel:[0,0] op_sel_hi:[1,0]
v_pk_fma_f16 v41, v40, v30, v41 op_sel:[1,1,0] op_sel_hi:[0,1,1] neg_hi:[1,0,0]
ds_write_addtid_b32 v41 offset:6912
ds_read_b128 v[64:67], v2 offset:4608
ds_read_b128 v[68:71], v2 offset:4672
ds_read_b128 v[72:75], v2 offset:4736
ds_read_b128 v[76:79], v2 offset:4800
v_add_u32 v10, s42, v44
v_add_u32 v12, s42, v45
v_add_u32 v13, s42, v46
v_add_u32 v14, s42, v47
s_waitcnt lgkmcnt(0)
v_mfma_f32_16x16x32_f16 v[88:91], v[64:67], v[48:51], 0
v_mfma_f32_16x16x32_f16 v[88:91], v[68:71], v[52:55], v[88:91]
v_mfma_f32_16x16x32_f16 v[88:91], v[72:75], v[56:59], v[88:91]
v_mfma_f32_16x16x32_f16 v[88:91], v[76:79], v[60:63], v[88:91]
ds_write_b128 v10, v[80:83]
ds_write_b64 v12, v[84:85]
ds_write_b64 v13, v[86:87]
s_nop 7
ds_write_b32 v14, v88 offset:0
ds_write_b32 v14, v89 offset:64
ds_write_b32 v14, v90 offset:128
ds_write_b32 v14, v91 offset:192
s_branch k1_kfin0b
k1_kfin0:
s_waitcnt lgkmcnt(0)
k1_kfin0b:
s_getpc_b64 s[68:69]
k1_pc3:
s_add_u32 s68, s68, k1_tab_g-k1_pc3
s_addc_u32 s69, s69, 0
v_lshlrev_b32 v4, 4, v0
global_load_dwordx4 v[28:31], v4, s[68:69]
s_waitcnt lgkmcnt(0)
s_barrier
k1_kfin1:
s_add_u32 s36, s14, 0x1500000
s_addc_u32 s37, s15, 0
s_mov_b32 s38, 0x280000
s_mov_b32 s39, 0x20000
s_waitcnt vmcnt(0)
v_lshlrev_b32 v4, 4, v0
v_and_b32 v32, 0xffff, v28
v_lshrrev_b32 v33, 16, v28
v_and_b32 v34, 0xffff, v29
v_lshrrev_b32 v35, 16, v29
v_and_b32 v36, 0xffff, v30
v_lshrrev_b32 v37, 16, v30
v_and_b32 v38, 0xffff, v31
v_lshrrev_b32 v39, 16, v31
v_cmp_gt_u32 vcc, 161, v0
s_and_saveexec_b64 s[44:45], vcc
s_cbranch_execz k1_ns_4
v_lshlrev_b32 v1, 4, v0
ds_read_b128 v[10:13], v1 offset:0
ds_read_b128 v[14:17], v1 offset:9216
ds_read_b128 v[18:21], v1 offset:18432
v_lshlrev_b32 v2, 3, v0
s_waitcnt lgkmcnt(0)
v_add_f32 v10, v10, v14
v_add_f32 v11, v11, v15
v_add_f32 v12, v12, v16
v_add_f32 v13, v13, v17
v_add_f32 v10, v10, v18
v_add_f32 v11, v11, v19
v_add_f32 v12, v12, v20
v_add_f32 v13, v13, v21
v_cvt_pk_f16_f32 v10, v10, v11
v_cvt_pk_f16_f32 v11, v12, v13
ds_write_b64 v2, v[10:11] offset:26336
k1_ns_4:
s_mov_b64 exec, s[44:45]
s_waitcnt lgkmcnt(0)
s_barrier
ds_read_u16 v48, v32
ds_read_u16 v49, v33
ds_read_u16 v50, v34
ds_read_u16 v51, v35
ds_read_u16 v52, v36
ds_read_u16 v53, v37
ds_read_u16 v54, v38
ds_read_u16 v55, v39
s_lshl_b32 s40, s61, 12
s_waitcnt lgkmcnt(0)
v_lshl_or_b32 v40, v49, 16, v48
v_lshl_or_b32 v41, v51, 16, v50
v_lshl_or_b32 v42, v53, 16, v52
v_lshl_or_b32 v43, v55, 16, v54
buffer_store_dwordx4 v[40:43], v4, s[36:39], s40 offen sc1
s_endpgm
.globl k2_kernel
.p2align 8
.type k2_kernel,@function
k2_kernel:
s_cmp_lt_u32 s2, 640
s_cbranch_scc1 k2_conv
s_cmp_lt_u32 s2, 760
s_cbranch_scc1 k2_prep
s_cmp_lt_u32 s2, 856
s_cbranch_scc1 k1_roleD
k2_exit:
s_endpgm
k2_conv:
v_lshrrev_b32 v1, 6, v0
s_nop 0
v_readfirstlane_b32 s3, v1
s_load_dwordx4 s[4:7], s[0:1], 40
s_load_dwordx2 s[14:15], s[0:1], 120
s_sub_u32 s40, s2, 0
s_lshl_b32 s41, s40, 12
s_lshl_b32 s43, s40, 2
s_lshl_b32 s44, s40, 1
s_and_b32 s44, s44, 0xfffffffc
v_lshlrev_b32 v1, 4, v0
v_lshlrev_b32 v2, 5, v0
s_lshl_b32 s42, s3, 10
s_add_u32 s42, s42, 32
s_add_u32 s52, s41, 0x200000
s_add_u32 s53, s41, 0x1500000
s_add_u32 s41, s41, 0x500000
s_mov_b32 s54, 0x4000
s_mov_b32 s55, 0x6000
s_waitcnt lgkmcnt(0)
s_mov_b32 s16, s14
s_mov_b32 s17, s15
s_mov_b32 s18, 0x1800000
s_mov_b32 s19, 0x20000
s_mov_b32 m0, s42
buffer_load_dwordx4 v[4:7], v1, s[16:19], s52 offen
buffer_load_dwordx4 v1, s[16:19], s53 offen lds
buffer_load_dwordx4 v[80:83], v2, s[16:19], s54 offen
buffer_load_dwordx4 v[84:87], v2, s[16:19], s54 offen offset:16
buffer_load_dwordx4 v[88:91], v2, s[16:19], s55 offen
buffer_load_dwordx4 v[92:95], v2, s[16:19], s55 offen offset:16
s_add_u32 s43, s43, 0x170000
s_add_u32 s12, s14, s43
s_addc_u32 s13, s15, 0
s_load_dword s45, s[12:13], 0
s_load_dword s56, s[12:13], 15360
s_load_dword s46, s[12:13], 2560
s_load_dword s57, s[12:13], 17920
s_load_dword s47, s[12:13], 5120
s_load_dword s58, s[12:13], 20480
s_load_dword s48, s[4:5], s44
s_load_dword s49, s[6:7], s44
v_mov_b32 v44, 0
v_lshrrev_b32 v45, 5, v0
v_mul_u32_u24 v45, 10240, v45
v_and_b32 v46, 31, v0
v_lshl_add_u32 v45, v46, 2, v45
v_cmp_gt_u32 vcc, 128, v0
s_and_saveexec_b64 s[52:53], vcc
ds_write_b32 v45, v44 offset:5184
s_mov_b64 exec, s[52:53]
v_lshlrev_b32 v45, 2, v0
v_cmp_gt_u32 vcc, 8, v0
s_and_saveexec_b64 s[52:53], vcc
ds_write_b32 v45, v44
s_mov_b64 exec, s[52:53]
s_waitcnt lgkmcnt(0)
s_and_b32 s51, s40, 1
s_lshl_b32 s51, s51, 4
s_lshr_b32 s48, s48, s51
s_lshl_b32 s48, s48, 16
s_lshr_b32 s49, s49, s51
s_lshl_b32 s49, s49, 16
v_mov_b32 v46, s48
v_mul_f32 v46, 0x3fb8aa3b, v46
v_exp_f32 v46, v46
v_mov_b32 v50, s45
v_add_f32 v50, s56, v50
v_mov_b32 v51, s46
v_add_f32 v51, s57, v51
v_mov_b32 v52, s47
v_add_f32 v52, s58, v52
v_cvt_pk_bf16_f32 v53, v50, v50
v_lshlrev_b32 v50, 16, v53
v_cvt_pk_bf16_f32 v53, v51, v51
v_lshlrev_b32 v51, 16, v53
v_cvt_pk_bf16_f32 v53, v52, v52
v_lshlrev_b32 v52, 16, v53
v_add_f32 v47, 1.0, v51
v_cvt_pk_bf16_f32 v48, v46, v46
v_lshlrev_b32 v46, 16, v48
v_cvt_pk_bf16_f32 v48, v47, v47
v_lshlrev_b32 v47, 16, v48
v_add_f32 v3, v46, v46
v_mul_f32 v3, v3, v52
v_mul_f32 v52, s49, v52
s_nop 0
v_readfirstlane_b32 s47, v52
v_readfirstlane_b32 s59, v47
v_mov_b32 v116, v50
v_and_b32 v44, 63, v0
v_lshrrev_b32 v45, 4, v44
v_bfe_u32 v46, v44, 2, 2
v_and_b32 v47, 3, v44
v_add_u32 v46, v46, v47
v_lshlrev_b32 v46, 3, v46
v_lshl_add_u32 v1, v45, 6, v46
v_add_u32 v1, 8, v1
v_and_b32 v46, 15, v44
s_mul_i32 s51, s3, 10240
s_add_u32 s51, s51, 4280
v_lshlrev_b32 v47, 3, v46
v_sub_u32 v2, s51, v47
v_lshl_add_u32 v2, v45, 4, v2
v_lshlrev_b32 v117, 2, v0
v_sub_u32 v117, 5180, v117
s_waitcnt vmcnt(0) lgkmcnt(0)
s_barrier
ds_read_b64_tr_b16 v[20:21], v1 offset:256
ds_read_b64_tr_b16 v[22:23], v1 offset:288
ds_read_b64_tr_b16 v[28:29], v1 offset:768
ds_read_b64_tr_b16 v[30:31], v1 offset:800
ds_read_b64_tr_b16 v[36:37], v1 offset:1280
ds_read_b64_tr_b16 v[38:39], v1 offset:1312
ds_read_b64_tr_b16 v[44:45], v1 offset:1792
ds_read_b64_tr_b16 v[46:47], v1 offset:1824
ds_read_b64_tr_b16 v[52:53], v1 offset:2304
ds_read_b64_tr_b16 v[54:55], v1 offset:2336
ds_read_b64_tr_b16 v[60:61], v1 offset:2816
ds_read_b64_tr_b16 v[62:63], v1 offset:2848
ds_read_b64_tr_b16 v[68:69], v1 offset:3328
ds_read_b64_tr_b16 v[70:71], v1 offset:3360
ds_read_b64_tr_b16 v[76:77], v1 offset:3840
ds_read_b64_tr_b16 v[78:79], v1 offset:3872
v_lshlrev_b32 v8, 16, v4
v_and_b32 v9, 0xffff0000, v4
v_lshlrev_b32 v10, 16, v5
v_and_b32 v11, 0xffff0000, v5
v_lshlrev_b32 v12, 16, v6
v_and_b32 v13, 0xffff0000, v6
v_lshlrev_b32 v14, 16, v7
v_and_b32 v15, 0xffff0000, v7
v_fma_f32 v8, v8, v80, v88
v_fma_f32 v9, v9, v81, v89
v_fma_f32 v10, v10, v82, v90
v_fma_f32 v11, v11, v83, v91
v_fma_f32 v12, v12, v84, v92
v_fma_f32 v13, v13, v85, v93
v_fma_f32 v14, v14, v86, v94
v_fma_f32 v15, v15, v87, v95
v_fma_f32 v8, v8, s59, v116
v_fma_f32 v9, v9, s59, v116
v_fma_f32 v10, v10, s59, v116
v_fma_f32 v11, v11, s59, v116
v_fma_f32 v12, v12, s59, v116
v_fma_f32 v13, v13, s59, v116
v_fma_f32 v14, v14, s59, v116
v_fma_f32 v15, v15, s59, v116
v_cvt_pk_f16_f32 v112, v12, v8
ds_write_b32 v117, v112 offset:0
v_cvt_pk_f16_f32 v113, v13, v9
ds_write_b32 v117, v113 offset:10240
v_cvt_pk_f16_f32 v114, v14, v10
ds_write_b32 v117, v114 offset:20480
v_cvt_pk_f16_f32 v115, v15, v11
ds_write_b32 v117, v115 offset:30720
ds_read_b64_tr_b16 v[16:17], v1 offset:0
ds_read_b64_tr_b16 v[18:19], v1 offset:32
ds_read_b64_tr_b16 v[24:25], v1 offset:512
ds_read_b64_tr_b16 v[26:27], v1 offset:544
ds_read_b64_tr_b16 v[32:33], v1 offset:1024
ds_read_b64_tr_b16 v[34:35], v1 offset:1056
ds_read_b64_tr_b16 v[40:41], v1 offset:1536
ds_read_b64_tr_b16 v[42:43], v1 offset:1568
ds_read_b64_tr_b16 v[48:49], v1 offset:2048
ds_read_b64_tr_b16 v[50:51], v1 offset:2080
ds_read_b64_tr_b16 v[56:57], v1 offset:2560
ds_read_b64_tr_b16 v[58:59], v1 offset:2592
ds_read_b64_tr_b16 v[64:65], v1 offset:3072
ds_read_b64_tr_b16 v[66:67], v1 offset:3104
ds_read_b64_tr_b16 v[72:73], v1 offset:3584
ds_read_b64_tr_b16 v[74:75], v1 offset:3616
s_waitcnt lgkmcnt(0)
s_barrier
ds_read_b64 v[112:113], v2 offset:960
ds_read_b64 v[114:115], v2 offset:968
ds_read_b64 v[116:117], v2 offset:896
ds_read_b64 v[118:119], v2 offset:904
s_waitcnt lgkmcnt(2)
v_mfma_f32_16x16x32_f16 v[80:83], v[20:23], v[112:115], 0
ds_read_b64 v[120:121], v2 offset:832
ds_read_b64 v[122:123], v2 offset:840
v_mfma_f32_16x16x32_f16 v[84:87], v[28:31], v[112:115], 0
ds_read_b64 v[124:125], v2 offset:768
ds_read_b64 v[126:127], v2 offset:776
v_mfma_f32_16x16x32_f16 v[88:91], v[36:39], v[112:115], 0
v_mfma_f32_16x16x32_f16 v[92:95], v[44:47], v[112:115], 0
v_mfma_f32_16x16x32_f16 v[96:99], v[52:55], v[112:115], 0
v_mfma_f32_16x16x32_f16 v[100:103], v[60:63], v[112:115], 0
v_mfma_f32_16x16x32_f16 v[104:107], v[68:71], v[112:115], 0
v_mfma_f32_16x16x32_f16 v[108:111], v[76:79], v[112:115], 0
ds_read_b64 v[112:113], v2 offset:704
ds_read_b64 v[114:115], v2 offset:712
s_waitcnt lgkmcnt(6)
v_mfma_f32_16x16x32_f16 v[80:83], v[16:19], v[116:119], v[80:83]
v_mfma_f32_16x16x32_f16 v[84:87], v[24:27], v[116:119], v[84:87]
v_mfma_f32_16x16x32_f16 v[88:91], v[32:35], v[116:119], v[88:91]
v_mfma_f32_16x16x32_f16 v[92:95], v[40:43], v[116:119], v[92:95]
v_mfma_f32_16x16x32_f16 v[96:99], v[48:51], v[116:119], v[96:99]
v_mfma_f32_16x16x32_f16 v[100:103], v[56:59], v[116:119], v[100:103]
v_mfma_f32_16x16x32_f16 v[104:107], v[64:67], v[116:119], v[104:107]
v_mfma_f32_16x16x32_f16 v[108:111], v[72:75], v[116:119], v[108:111]
ds_read_b64 v[116:117], v2 offset:640
ds_read_b64 v[118:119], v2 offset:648
s_waitcnt lgkmcnt(6)
v_mfma_f32_16x16x32_f16 v[84:87], v[20:23], v[120:123], v[84:87]
v_mfma_f32_16x16x32_f16 v[88:91], v[28:31], v[120:123], v[88:91]
v_mfma_f32_16x16x32_f16 v[92:95], v[36:39], v[120:123], v[92:95]
v_mfma_f32_16x16x32_f16 v[96:99], v[44:47], v[120:123], v[96:99]
v_mfma_f32_16x16x32_f16 v[100:103], v[52:55], v[120:123], v[100:103]
v_mfma_f32_16x16x32_f16 v[104:107], v[60:63], v[120:123], v[104:107]
v_mfma_f32_16x16x32_f16 v[108:111], v[68:71], v[120:123], v[108:111]
ds_read_b64 v[120:121], v2 offset:576
ds_read_b64 v[122:123], v2 offset:584
s_waitcnt lgkmcnt(6)
v_mfma_f32_16x16x32_f16 v[84:87], v[16:19], v[124:127], v[84:87]
v_mfma_f32_16x16x32_f16 v[88:91], v[24:27], v[124:127], v[88:91]
v_mfma_f32_16x16x32_f16 v[92:95], v[32:35], v[124:127], v[92:95]
v_mfma_f32_16x16x32_f16 v[96:99], v[40:43], v[124:127], v[96:99]
v_mfma_f32_16x16x32_f16 v[100:103], v[48:51], v[124:127], v[100:103]
v_mfma_f32_16x16x32_f16 v[104:107], v[56:59], v[124:127], v[104:107]
v_mfma_f32_16x16x32_f16 v[108:111], v[64:67], v[124:127], v[108:111]
ds_read_b64 v[124:125], v2 offset:512
ds_read_b64 v[126:127], v2 offset:520
s_waitcnt lgkmcnt(6)
v_mfma_f32_16x16x32_f16 v[88:91], v[20:23], v[112:115], v[88:91]
v_mfma_f32_16x16x32_f16 v[92:95], v[28:31], v[112:115], v[92:95]
v_mfma_f32_16x16x32_f16 v[96:99], v[36:39], v[112:115], v[96:99]
v_mfma_f32_16x16x32_f16 v[100:103], v[44:47], v[112:115], v[100:103]
v_mfma_f32_16x16x32_f16 v[104:107], v[52:55], v[112:115], v[104:107]
v_mfma_f32_16x16x32_f16 v[108:111], v[60:63], v[112:115], v[108:111]
ds_read_b64 v[112:113], v2 offset:448
ds_read_b64 v[114:115], v2 offset:456
s_waitcnt lgkmcnt(6)
v_mfma_f32_16x16x32_f16 v[88:91], v[16:19], v[116:119], v[88:91]
v_mfma_f32_16x16x32_f16 v[92:95], v[24:27], v[116:119], v[92:95]
v_mfma_f32_16x16x32_f16 v[96:99], v[32:35], v[116:119], v[96:99]
v_mfma_f32_16x16x32_f16 v[100:103], v[40:43], v[116:119], v[100:103]
v_mfma_f32_16x16x32_f16 v[104:107], v[48:51], v[116:119], v[104:107]
v_mfma_f32_16x16x32_f16 v[108:111], v[56:59], v[116:119], v[108:111]
ds_read_b64 v[116:117], v2 offset:384
ds_read_b64 v[118:119], v2 offset:392
s_waitcnt lgkmcnt(6)
v_mfma_f32_16x16x32_f16 v[92:95], v[20:23], v[120:123], v[92:95]
v_mfma_f32_16x16x32_f16 v[96:99], v[28:31], v[120:123], v[96:99]
v_mfma_f32_16x16x32_f16 v[100:103], v[36:39], v[120:123], v[100:103]
v_mfma_f32_16x16x32_f16 v[104:107], v[44:47], v[120:123], v[104:107]
v_mfma_f32_16x16x32_f16 v[108:111], v[52:55], v[120:123], v[108:111]
ds_read_b64 v[120:121], v2 offset:320
ds_read_b64 v[122:123], v2 offset:328
s_waitcnt lgkmcnt(6)
v_mfma_f32_16x16x32_f16 v[92:95], v[16:19], v[124:127], v[92:95]
v_mfma_f32_16x16x32_f16 v[96:99], v[24:27], v[124:127], v[96:99]
v_mfma_f32_16x16x32_f16 v[100:103], v[32:35], v[124:127], v[100:103]
v_mfma_f32_16x16x32_f16 v[104:107], v[40:43], v[124:127], v[104:107]
v_mfma_f32_16x16x32_f16 v[108:111], v[48:51], v[124:127], v[108:111]
ds_read_b64 v[124:125], v2 offset:256
ds_read_b64 v[126:127], v2 offset:264
s_waitcnt lgkmcnt(6)
v_mfma_f32_16x16x32_f16 v[96:99], v[20:23], v[112:115], v[96:99]
v_mfma_f32_16x16x32_f16 v[100:103], v[28:31], v[112:115], v[100:103]
v_mfma_f32_16x16x32_f16 v[104:107], v[36:39], v[112:115], v[104:107]
v_mfma_f32_16x16x32_f16 v[108:111], v[44:47], v[112:115], v[108:111]
ds_read_b64 v[112:113], v2 offset:192
ds_read_b64 v[114:115], v2 offset:200
s_waitcnt lgkmcnt(6)
v_mfma_f32_16x16x32_f16 v[96:99], v[16:19], v[116:119], v[96:99]
v_mfma_f32_16x16x32_f16 v[100:103], v[24:27], v[116:119], v[100:103]
v_mfma_f32_16x16x32_f16 v[104:107], v[32:35], v[116:119], v[104:107]
v_mfma_f32_16x16x32_f16 v[108:111], v[40:43], v[116:119], v[108:111]
ds_read_b64 v[116:117], v2 offset:128
ds_read_b64 v[118:119], v2 offset:136
s_waitcnt lgkmcnt(6)
v_mfma_f32_16x16x32_f16 v[100:103], v[20:23], v[120:123], v[100:103]
v_mfma_f32_16x16x32_f16 v[104:107], v[28:31], v[120:123], v[104:107]
v_mfma_f32_16x16x32_f16 v[108:111], v[36:39], v[120:123], v[108:111]
ds_read_b64 v[120:121], v2 offset:64
ds_read_b64 v[122:123], v2 offset:72
s_waitcnt lgkmcnt(6)
v_mfma_f32_16x16x32_f16 v[100:103], v[16:19], v[124:127], v[100:103]
v_mfma_f32_16x16x32_f16 v[104:107], v[24:27], v[124:127], v[104:107]
v_mfma_f32_16x16x32_f16 v[108:111], v[32:35], v[124:127], v[108:111]
ds_read_b64 v[124:125], v2 offset:0
ds_read_b64 v[126:127], v2 offset:8
s_waitcnt lgkmcnt(6)
v_mfma_f32_16x16x32_f16 v[104:107], v[20:23], v[112:115], v[104:107]
v_mfma_f32_16x16x32_f16 v[108:111], v[28:31], v[112:115], v[108:111]
s_waitcnt lgkmcnt(4)
v_mfma_f32_16x16x32_f16 v[104:107], v[16:19], v[116:119], v[104:107]
v_mfma_f32_16x16x32_f16 v[108:111], v[24:27], v[116:119], v[108:111]
s_waitcnt lgkmcnt(2)
v_mfma_f32_16x16x32_f16 v[108:111], v[20:23], v[120:123], v[108:111]
s_waitcnt lgkmcnt(0)
v_mfma_f32_16x16x32_f16 v[108:111], v[16:19], v[124:127], v[108:111]
v_and_b32 v1, 15, v0
v_bfe_u32 v2, v0, 4, 2
v_mul_u32_u24 v1, 80, v1
v_lshl_add_u32 v1, v2, 4, v1
s_mul_i32 s51, s3, 10240
s_add_u32 s51, s51, 0
v_add_u32 v1, s51, v1
s_nop 2
ds_write_b128 v1, v[80:83] offset:0
ds_write_b128 v1, v[84:87] offset:1280
ds_write_b128 v1, v[88:91] offset:2560
ds_write_b128 v1, v[92:95] offset:3840
ds_write_b128 v1, v[96:99] offset:5120
ds_write_b128 v1, v[100:103] offset:6400
ds_write_b128 v1, v[104:107] offset:7680
ds_write_b128 v1, v[108:111] offset:8960
v_lshrrev_b32 v1, 1, v0
v_mul_u32_u24 v1, 80, v1
v_and_b32 v2, 1, v0
v_lshl_add_u32 v1, v2, 5, v1
v_lshlrev_b32 v2, 4, v2
v_add_u32 v2, v1, v2
v_subrev_u32 v2, 32, v2
v_mov_b32 v28, 0
v_mov_b32 v29, 0
v_mov_b32 v30, 0
v_mov_b32 v31, 0
v_mov_b32 v40, 0
v_mov_b32 v41, 0
v_mov_b32 v42, 0
v_mov_b32 v43, 0
v_mov_b32 v52, 0
v_mov_b32 v53, 0
v_mov_b32 v54, 0
v_mov_b32 v55, 0
s_waitcnt lgkmcnt(0)
s_barrier
ds_read_b128 v[20:23], v1 offset:0
ds_read_b128 v[24:27], v1 offset:16
ds_read_b128 v[32:35], v1 offset:10240
ds_read_b128 v[36:39], v1 offset:10256
ds_read_b128 v[44:47], v1 offset:20480
ds_read_b128 v[48:51], v1 offset:20496
ds_read_b128 v[56:59], v1 offset:30720
ds_read_b128 v[60:63], v1 offset:30736
v_cmp_lt_u32 vcc, 0, v0
s_and_saveexec_b64 s[52:53], vcc
ds_read_b128 v[28:31], v2 offset:10240
ds_read_b128 v[40:43], v2 offset:20480
ds_read_b128 v[52:55], v2 offset:30720
s_mov_b64 exec, s[52:53]
v_lshlrev_b32 v1, 4, v0
s_waitcnt lgkmcnt(0)
v_add_f32 v64, v20, v31
v_add_f32 v65, v21, v32
v_add_f32 v66, v22, v33
v_add_f32 v67, v23, v34
v_add_f32 v68, v24, v35
v_add_f32 v69, v25, v36
v_add_f32 v70, v26, v37
v_add_f32 v71, v27, v38
v_add_f32 v64, v64, v42
v_add_f32 v65, v65, v43
v_add_f32 v66, v66, v44
v_add_f32 v67, v67, v45
v_add_f32 v68, v68, v46
v_add_f32 v69, v69, v47
v_add_f32 v70, v70, v48
v_add_f32 v71, v71, v49
v_add_f32 v64, v64, v53
v_add_f32 v65, v65, v54
v_add_f32 v66, v66, v55
v_add_f32 v67, v67, v56
v_add_f32 v68, v68, v57
v_add_f32 v69, v69, v58
v_add_f32 v70, v70, v59
v_add_f32 v71, v71, v60
v_lshlrev_b32 v72, 16, v4
v_and_b32 v73, 0xffff0000, v4
v_lshlrev_b32 v74, 16, v5
v_and_b32 v75, 0xffff0000, v5
v_lshlrev_b32 v76, 16, v6
v_and_b32 v77, 0xffff0000, v6
v_lshlrev_b32 v78, 16, v7
v_and_b32 v79, 0xffff0000, v7
v_fma_f32 v72, v8, s47, v72
v_fma_f32 v73, v9, s47, v73
v_fma_f32 v74, v10, s47, v74
v_fma_f32 v75, v11, s47, v75
v_fma_f32 v76, v12, s47, v76
v_fma_f32 v77, v13, s47, v77
v_fma_f32 v78, v14, s47, v78
v_fma_f32 v79, v15, s47, v79
v_fma_f32 v64, v64, v3, v72
v_fma_f32 v65, v65, v3, v73
v_fma_f32 v66, v66, v3, v74
v_fma_f32 v67, v67, v3, v75
v_fma_f32 v68, v68, v3, v76
v_fma_f32 v69, v69, v3, v77
v_fma_f32 v70, v70, v3, v78
v_fma_f32 v71, v71, v3, v79
v_cvt_pk_bf16_f32 v72, v64, v65
v_cvt_pk_bf16_f32 v73, v66, v67
v_cvt_pk_bf16_f32 v74, v68, v69
v_cvt_pk_bf16_f32 v75, v70, v71
buffer_store_dwordx4 v[72:75], v1, s[16:19], s41 offen sc1
s_waitcnt vmcnt(0)
s_endpgm
k2_prep:
v_lshrrev_b32 v1, 6, v0
s_nop 0
v_readfirstlane_b32 s3, v1
s_load_dwordx4 s[4:7], s[0:1], 64
s_load_dwordx2 s[14:15], s[0:1], 120
s_sub_u32 s61, s2, 640
s_cmp_ge_u32 s61, 60
s_cselect_b32 s40, 1, 0
s_mul_i32 s41, s40, 60
s_sub_u32 s41, s61, s41
s_mul_i32 s42, s41, 6554
s_lshr_b32 s42, s42, 16
s_mul_i32 s43, s42, 10
s_sub_u32 s43, s41, s43
s_lshl_b32 s44, s43, 2
s_add_u32 s44, s44, s3
v_and_b32 v1, 63, v0
v_and_b32 v2, 31, v1
v_lshrrev_b32 v3, 5, v1
v_mul_u32_u24 v4, 24576, v3
v_lshl_add_u32 v4, v2, 4, v4
v_lshlrev_b32 v5, 5, v3
s_mul_i32 s45, s44, 49152
s_lshl_b32 s46, s42, 9
s_add_u32 s45, s45, s46
s_lshl_b32 s46, s44, 6
s_add_u32 s47, s46, 7680
s_add_u32 s46, s46, 10240
s_waitcnt lgkmcnt(0)
s_cmp_eq_u32 s40, 0
s_cselect_b32 s4, s4, s6
s_cselect_b32 s5, s5, s7
s_mov_b32 s16, s4
s_mov_b32 s17, s5
s_mov_b32 s18, 0x1e0000
s_mov_b32 s19, 0x20000
s_add_u32 s20, s14, 0x170000
s_addc_u32 s21, s15, 0
s_mov_b32 s22, 0x7800
s_mov_b32 s23, 0x20000
s_add_u32 s24, s14, 0x800000
s_addc_u32 s25, s15, 0
s_mov_b32 s26, 0x3c0000
s_mov_b32 s27, 0x20000
s_add_u32 s28, s14, 0x10000
s_addc_u32 s29, s15, 0
s_mov_b32 s30, 0x3c000
s_mov_b32 s31, 0x20000
s_cmp_lg_u32 s61, 0
s_cbranch_scc1 k2_zf_5
s_add_u32 s32, s14, 0x160000
s_addc_u32 s33, s15, 0
s_mov_b32 s34, 0x5000
s_mov_b32 s35, 0x20000
v_lshlrev_b32 v6, 4, v0
v_mov_b32 v8, 0
v_mov_b32 v9, 0
v_mov_b32 v10, 0
v_mov_b32 v11, 0
buffer_store_dwordx4 v[8:11], v6, s[32:35], 0 offen sc1
v_add_u32 v6, 4096, v6
buffer_store_dwordx4 v[8:11], v6, s[32:35], 0 offen sc1
v_add_u32 v6, 4096, v6
buffer_store_dwordx4 v[8:11], v6, s[32:35], 0 offen sc1
v_add_u32 v6, 4096, v6
buffer_store_dwordx4 v[8:11], v6, s[32:35], 0 offen sc1
v_add_u32 v6, 4096, v6
buffer_store_dwordx4 v[8:11], v6, s[32:35], 0 offen sc1
v_add_u32 v6, 4096, v6
s_nop 1
k2_zf_5:
buffer_load_dwordx4 v[8:11], v5, s[20:23], s46 offen
buffer_load_dwordx4 v[12:15], v5, s[20:23], s46 offen offset:16
buffer_load_dwordx4 v[16:19], v5, s[20:23], s47 offen
buffer_load_dwordx4 v[20:23], v5, s[20:23], s47 offen offset:16
s_add_u32 s46, s46, 15360
s_add_u32 s47, s47, 15360
buffer_load_dwordx4 v[108:111], v5, s[20:23], s46 offen
buffer_load_dwordx4 v[112:115], v5, s[20:23], s46 offen offset:16
buffer_load_dwordx4 v[116:119], v5, s[20:23], s47 offen
buffer_load_dwordx4 v[120:123], v5, s[20:23], s47 offen offset:16
buffer_load_dwordx4 v[24:27], v4, s[16:19], s45 offen
s_add_u32 s45, s45, 3072
buffer_load_dwordx4 v[28:31], v4, s[16:19], s45 offen
s_add_u32 s45, s45, 3072
buffer_load_dwordx4 v[32:35], v4, s[16:19], s45 offen
s_add_u32 s45, s45, 3072
buffer_load_dwordx4 v[36:39], v4, s[16:19], s45 offen
s_add_u32 s45, s45, 3072
buffer_load_dwordx4 v[40:43], v4, s[16:19], s45 offen
s_add_u32 s45, s45, 3072
buffer_load_dwordx4 v[44:47], v4, s[16:19], s45 offen
s_add_u32 s45, s45, 3072
buffer_load_dwordx4 v[48:51], v4, s[16:19], s45 offen
s_add_u32 s45, s45, 3072
buffer_load_dwordx4 v[52:55], v4, s[16:19], s45 offen
v_mov_b32 v88, 0
v_mov_b32 v89, 0
v_mov_b32 v90, 0
v_mov_b32 v91, 0
v_mov_b32 v92, 0
v_mov_b32 v93, 0
v_mov_b32 v94, 0
v_mov_b32 v95, 0
v_mov_b32 v96, 0
v_mov_b32 v97, 0
v_mov_b32 v98, 0
v_mov_b32 v99, 0
v_mov_b32 v100, 0
v_mov_b32 v101, 0
v_mov_b32 v102, 0
v_mov_b32 v103, 0
s_waitcnt vmcnt(8)
v_add_f32 v8, v8, v108
v_add_f32 v9, v9, v109
v_add_f32 v10, v10, v110
v_add_f32 v11, v11, v111
v_add_f32 v12, v12, v112
v_add_f32 v13, v13, v113
v_add_f32 v14, v14, v114
v_add_f32 v15, v15, v115
v_add_f32 v16, v16, v116
v_add_f32 v17, v17, v117
v_add_f32 v18, v18, v118
v_add_f32 v19, v19, v119
v_add_f32 v20, v20, v120
v_add_f32 v21, v21, v121
v_add_f32 v22, v22, v122
v_add_f32 v23, v23, v123
v_cvt_pk_bf16_f32 v104, v8, v8
v_lshlrev_b32 v8, 16, v104
v_cvt_pk_bf16_f32 v104, v9, v9
v_lshlrev_b32 v9, 16, v104
v_cvt_pk_bf16_f32 v104, v10, v10
v_lshlrev_b32 v10, 16, v104
v_cvt_pk_bf16_f32 v104, v11, v11
v_lshlrev_b32 v11, 16, v104
v_cvt_pk_bf16_f32 v104, v12, v12
v_lshlrev_b32 v12, 16, v104
v_cvt_pk_bf16_f32 v104, v13, v13
v_lshlrev_b32 v13, 16, v104
v_cvt_pk_bf16_f32 v104, v14, v14
v_lshlrev_b32 v14, 16, v104
v_cvt_pk_bf16_f32 v104, v15, v15
v_lshlrev_b32 v15, 16, v104
v_cvt_pk_bf16_f32 v104, v16, v16
v_lshlrev_b32 v16, 16, v104
v_cvt_pk_bf16_f32 v104, v17, v17
v_lshlrev_b32 v17, 16, v104
v_cvt_pk_bf16_f32 v104, v18, v18
v_lshlrev_b32 v18, 16, v104
v_cvt_pk_bf16_f32 v104, v19, v19
v_lshlrev_b32 v19, 16, v104
v_cvt_pk_bf16_f32 v104, v20, v20
v_lshlrev_b32 v20, 16, v104
v_cvt_pk_bf16_f32 v104, v21, v21
v_lshlrev_b32 v21, 16, v104
v_cvt_pk_bf16_f32 v104, v22, v22
v_lshlrev_b32 v22, 16, v104
v_cvt_pk_bf16_f32 v104, v23, v23
v_lshlrev_b32 v23, 16, v104
v_add_f32 v8, 1.0, v8
v_add_f32 v9, 1.0, v9
v_add_f32 v10, 1.0, v10
v_add_f32 v11, 1.0, v11
v_add_f32 v12, 1.0, v12
v_add_f32 v13, 1.0, v13
v_add_f32 v14, 1.0, v14
v_add_f32 v15, 1.0, v15
v_cvt_pk_bf16_f32 v104, v8, v8
v_lshlrev_b32 v8, 16, v104
v_cvt_pk_bf16_f32 v104, v9, v9
v_lshlrev_b32 v9, 16, v104
v_cvt_pk_bf16_f32 v104, v10, v10
v_lshlrev_b32 v10, 16, v104
v_cvt_pk_bf16_f32 v104, v11, v11
v_lshlrev_b32 v11, 16, v104
v_cvt_pk_bf16_f32 v104, v12, v12
v_lshlrev_b32 v12, 16, v104
v_cvt_pk_bf16_f32 v104, v13, v13
v_lshlrev_b32 v13, 16, v104
v_cvt_pk_bf16_f32 v104, v14, v14
v_lshlrev_b32 v14, 16, v104
v_cvt_pk_bf16_f32 v104, v15, v15
v_lshlrev_b32 v15, 16, v104
s_waitcnt vmcnt(6)
v_lshlrev_b32 v104, 16, v24
v_and_b32 v105, 0xffff0000, v24
v_lshlrev_b32 v106, 16, v28
v_and_b32 v107, 0xffff0000, v28
v_fmac_f32 v89, v16, v104
v_fmac_f32 v91, v16, v105
v_fmac_f32 v89, v17, v106
v_fmac_f32 v91, v17, v107
v_mul_f32 v104, v8, v104
v_mul_f32 v105, v8, v105
v_mul_f32 v106, v9, v106
v_mul_f32 v107, v9, v107
v_add_f32 v88, v88, v104
v_add_f32 v90, v90, v105
v_add_f32 v88, v88, v106
v_add_f32 v90, v90, v107
v_cvt_pk_bf16_f32 v56, v104, v106
v_cvt_pk_bf16_f32 v60, v105, v107
v_lshlrev_b32 v104, 16, v25
v_and_b32 v105, 0xffff0000, v25
v_lshlrev_b32 v106, 16, v29
v_and_b32 v107, 0xffff0000, v29
v_fmac_f32 v93, v16, v104
v_fmac_f32 v95, v16, v105
v_fmac_f32 v93, v17, v106
v_fmac_f32 v95, v17, v107
v_mul_f32 v104, v8, v104
v_mul_f32 v105, v8, v105
v_mul_f32 v106, v9, v106
v_mul_f32 v107, v9, v107
v_add_f32 v92, v92, v104
v_add_f32 v94, v94, v105
v_add_f32 v92, v92, v106
v_add_f32 v94, v94, v107
v_cvt_pk_bf16_f32 v64, v104, v106
v_cvt_pk_bf16_f32 v68, v105, v107
v_lshlrev_b32 v104, 16, v26
v_and_b32 v105, 0xffff0000, v26
v_lshlrev_b32 v106, 16, v30
v_and_b32 v107, 0xffff0000, v30
v_fmac_f32 v97, v16, v104
v_fmac_f32 v99, v16, v105
v_fmac_f32 v97, v17, v106
v_fmac_f32 v99, v17, v107
v_mul_f32 v104, v8, v104
v_mul_f32 v105, v8, v105
v_mul_f32 v106, v9, v106
v_mul_f32 v107, v9, v107
v_add_f32 v96, v96, v104
v_add_f32 v98, v98, v105
v_add_f32 v96, v96, v106
v_add_f32 v98, v98, v107
v_cvt_pk_bf16_f32 v72, v104, v106
v_cvt_pk_bf16_f32 v76, v105, v107
v_lshlrev_b32 v104, 16, v27
v_and_b32 v105, 0xffff0000, v27
v_lshlrev_b32 v106, 16, v31
v_and_b32 v107, 0xffff0000, v31
v_fmac_f32 v101, v16, v104
v_fmac_f32 v103, v16, v105
v_fmac_f32 v101, v17, v106
v_fmac_f32 v103, v17, v107
v_mul_f32 v104, v8, v104
v_mul_f32 v105, v8, v105
v_mul_f32 v106, v9, v106
v_mul_f32 v107, v9, v107
v_add_f32 v100, v100, v104
v_add_f32 v102, v102, v105
v_add_f32 v100, v100, v106
v_add_f32 v102, v102, v107
v_cvt_pk_bf16_f32 v80, v104, v106
v_cvt_pk_bf16_f32 v84, v105, v107
s_waitcnt vmcnt(4)
v_lshlrev_b32 v104, 16, v32
v_and_b32 v105, 0xffff0000, v32
v_lshlrev_b32 v106, 16, v36
v_and_b32 v107, 0xffff0000, v36
v_fmac_f32 v89, v18, v104
v_fmac_f32 v91, v18, v105
v_fmac_f32 v89, v19, v106
v_fmac_f32 v91, v19, v107
v_mul_f32 v104, v10, v104
v_mul_f32 v105, v10, v105
v_mul_f32 v106, v11, v106
v_mul_f32 v107, v11, v107
v_add_f32 v88, v88, v104
v_add_f32 v90, v90, v105
v_add_f32 v88, v88, v106
v_add_f32 v90, v90, v107
v_cvt_pk_bf16_f32 v57, v104, v106
v_cvt_pk_bf16_f32 v61, v105, v107
v_lshlrev_b32 v104, 16, v33
v_and_b32 v105, 0xffff0000, v33
v_lshlrev_b32 v106, 16, v37
v_and_b32 v107, 0xffff0000, v37
v_fmac_f32 v93, v18, v104
v_fmac_f32 v95, v18, v105
v_fmac_f32 v93, v19, v106
v_fmac_f32 v95, v19, v107
v_mul_f32 v104, v10, v104
v_mul_f32 v105, v10, v105
v_mul_f32 v106, v11, v106
v_mul_f32 v107, v11, v107
v_add_f32 v92, v92, v104
v_add_f32 v94, v94, v105
v_add_f32 v92, v92, v106
v_add_f32 v94, v94, v107
v_cvt_pk_bf16_f32 v65, v104, v106
v_cvt_pk_bf16_f32 v69, v105, v107
v_lshlrev_b32 v104, 16, v34
v_and_b32 v105, 0xffff0000, v34
v_lshlrev_b32 v106, 16, v38
v_and_b32 v107, 0xffff0000, v38
v_fmac_f32 v97, v18, v104
v_fmac_f32 v99, v18, v105
v_fmac_f32 v97, v19, v106
v_fmac_f32 v99, v19, v107
v_mul_f32 v104, v10, v104
v_mul_f32 v105, v10, v105
v_mul_f32 v106, v11, v106
v_mul_f32 v107, v11, v107
v_add_f32 v96, v96, v104
v_add_f32 v98, v98, v105
v_add_f32 v96, v96, v106
v_add_f32 v98, v98, v107
v_cvt_pk_bf16_f32 v73, v104, v106
v_cvt_pk_bf16_f32 v77, v105, v107
v_lshlrev_b32 v104, 16, v35
v_and_b32 v105, 0xffff0000, v35
v_lshlrev_b32 v106, 16, v39
v_and_b32 v107, 0xffff0000, v39
v_fmac_f32 v101, v18, v104
v_fmac_f32 v103, v18, v105
v_fmac_f32 v101, v19, v106
v_fmac_f32 v103, v19, v107
v_mul_f32 v104, v10, v104
v_mul_f32 v105, v10, v105
v_mul_f32 v106, v11, v106
v_mul_f32 v107, v11, v107
v_add_f32 v100, v100, v104
v_add_f32 v102, v102, v105
v_add_f32 v100, v100, v106
v_add_f32 v102, v102, v107
v_cvt_pk_bf16_f32 v81, v104, v106
v_cvt_pk_bf16_f32 v85, v105, v107
s_waitcnt vmcnt(2)
v_lshlrev_b32 v104, 16, v40
v_and_b32 v105, 0xffff0000, v40
v_lshlrev_b32 v106, 16, v44
v_and_b32 v107, 0xffff0000, v44
v_fmac_f32 v89, v20, v104
v_fmac_f32 v91, v20, v105
v_fmac_f32 v89, v21, v106
v_fmac_f32 v91, v21, v107
v_mul_f32 v104, v12, v104
v_mul_f32 v105, v12, v105
v_mul_f32 v106, v13, v106
v_mul_f32 v107, v13, v107
v_add_f32 v88, v88, v104
v_add_f32 v90, v90, v105
v_add_f32 v88, v88, v106
v_add_f32 v90, v90, v107
v_cvt_pk_bf16_f32 v58, v104, v106
v_cvt_pk_bf16_f32 v62, v105, v107
v_lshlrev_b32 v104, 16, v41
v_and_b32 v105, 0xffff0000, v41
v_lshlrev_b32 v106, 16, v45
v_and_b32 v107, 0xffff0000, v45
v_fmac_f32 v93, v20, v104
v_fmac_f32 v95, v20, v105
v_fmac_f32 v93, v21, v106
v_fmac_f32 v95, v21, v107
v_mul_f32 v104, v12, v104
v_mul_f32 v105, v12, v105
v_mul_f32 v106, v13, v106
v_mul_f32 v107, v13, v107
v_add_f32 v92, v92, v104
v_add_f32 v94, v94, v105
v_add_f32 v92, v92, v106
v_add_f32 v94, v94, v107
v_cvt_pk_bf16_f32 v66, v104, v106
v_cvt_pk_bf16_f32 v70, v105, v107
v_lshlrev_b32 v104, 16, v42
v_and_b32 v105, 0xffff0000, v42
v_lshlrev_b32 v106, 16, v46
v_and_b32 v107, 0xffff0000, v46
v_fmac_f32 v97, v20, v104
v_fmac_f32 v99, v20, v105
v_fmac_f32 v97, v21, v106
v_fmac_f32 v99, v21, v107
v_mul_f32 v104, v12, v104
v_mul_f32 v105, v12, v105
v_mul_f32 v106, v13, v106
v_mul_f32 v107, v13, v107
v_add_f32 v96, v96, v104
v_add_f32 v98, v98, v105
v_add_f32 v96, v96, v106
v_add_f32 v98, v98, v107
v_cvt_pk_bf16_f32 v74, v104, v106
v_cvt_pk_bf16_f32 v78, v105, v107
v_lshlrev_b32 v104, 16, v43
v_and_b32 v105, 0xffff0000, v43
v_lshlrev_b32 v106, 16, v47
v_and_b32 v107, 0xffff0000, v47
v_fmac_f32 v101, v20, v104
v_fmac_f32 v103, v20, v105
v_fmac_f32 v101, v21, v106
v_fmac_f32 v103, v21, v107
v_mul_f32 v104, v12, v104
v_mul_f32 v105, v12, v105
v_mul_f32 v106, v13, v106
v_mul_f32 v107, v13, v107
v_add_f32 v100, v100, v104
v_add_f32 v102, v102, v105
v_add_f32 v100, v100, v106
v_add_f32 v102, v102, v107
v_cvt_pk_bf16_f32 v82, v104, v106
v_cvt_pk_bf16_f32 v86, v105, v107
s_waitcnt vmcnt(0)
v_lshlrev_b32 v104, 16, v48
v_and_b32 v105, 0xffff0000, v48
v_lshlrev_b32 v106, 16, v52
v_and_b32 v107, 0xffff0000, v52
v_fmac_f32 v89, v22, v104
v_fmac_f32 v91, v22, v105
v_fmac_f32 v89, v23, v106
v_fmac_f32 v91, v23, v107
v_mul_f32 v104, v14, v104
v_mul_f32 v105, v14, v105
v_mul_f32 v106, v15, v106
v_mul_f32 v107, v15, v107
v_add_f32 v88, v88, v104
v_add_f32 v90, v90, v105
v_add_f32 v88, v88, v106
v_add_f32 v90, v90, v107
v_cvt_pk_bf16_f32 v59, v104, v106
v_cvt_pk_bf16_f32 v63, v105, v107
v_lshlrev_b32 v104, 16, v49
v_and_b32 v105, 0xffff0000, v49
v_lshlrev_b32 v106, 16, v53
v_and_b32 v107, 0xffff0000, v53
v_fmac_f32 v93, v22, v104
v_fmac_f32 v95, v22, v105
v_fmac_f32 v93, v23, v106
v_fmac_f32 v95, v23, v107
v_mul_f32 v104, v14, v104
v_mul_f32 v105, v14, v105
v_mul_f32 v106, v15, v106
v_mul_f32 v107, v15, v107
v_add_f32 v92, v92, v104
v_add_f32 v94, v94, v105
v_add_f32 v92, v92, v106
v_add_f32 v94, v94, v107
v_cvt_pk_bf16_f32 v67, v104, v106
v_cvt_pk_bf16_f32 v71, v105, v107
v_lshlrev_b32 v104, 16, v50
v_and_b32 v105, 0xffff0000, v50
v_lshlrev_b32 v106, 16, v54
v_and_b32 v107, 0xffff0000, v54
v_fmac_f32 v97, v22, v104
v_fmac_f32 v99, v22, v105
v_fmac_f32 v97, v23, v106
v_fmac_f32 v99, v23, v107
v_mul_f32 v104, v14, v104
v_mul_f32 v105, v14, v105
v_mul_f32 v106, v15, v106
v_mul_f32 v107, v15, v107
v_add_f32 v96, v96, v104
v_add_f32 v98, v98, v105
v_add_f32 v96, v96, v106
v_add_f32 v98, v98, v107
v_cvt_pk_bf16_f32 v75, v104, v106
v_cvt_pk_bf16_f32 v79, v105, v107
v_lshlrev_b32 v104, 16, v51
v_and_b32 v105, 0xffff0000, v51
v_lshlrev_b32 v106, 16, v55
v_and_b32 v107, 0xffff0000, v55
v_fmac_f32 v101, v22, v104
v_fmac_f32 v103, v22, v105
v_fmac_f32 v101, v23, v106
v_fmac_f32 v103, v23, v107
v_mul_f32 v104, v14, v104
v_mul_f32 v105, v14, v105
v_mul_f32 v106, v15, v106
v_mul_f32 v107, v15, v107
v_add_f32 v100, v100, v104
v_add_f32 v102, v102, v105
v_add_f32 v100, v100, v106
v_add_f32 v102, v102, v107
v_cvt_pk_bf16_f32 v83, v104, v106
v_cvt_pk_bf16_f32 v87, v105, v107
v_and_b32 v6, 15, v1
v_lshlrev_b32 v6, 4, v6
v_lshl_add_u32 v6, v3, 9, v6
s_lshl_b32 s51, s40, 8
v_add_u32 v6, s51, v6
v_bfe_u32 v7, v1, 4, 1
v_cmp_eq_u32 vcc, 1, v7
s_lshl_b32 s48, s42, 4
s_add_u32 s48, s48, 0
s_mul_i32 s49, s48, 10923
s_lshr_b32 s49, s49, 16
s_mul_i32 s50, s49, 6
s_sub_u32 s50, s48, s50
s_mul_i32 s49, s49, 40
s_add_u32 s49, s49, s44
s_mul_i32 s49, s49, 6
s_add_u32 s49, s49, s50
s_lshl_b32 s52, s49, 10
s_lshl_b32 s48, s42, 4
s_add_u32 s48, s48, 8
s_mul_i32 s49, s48, 10923
s_lshr_b32 s49, s49, 16
s_mul_i32 s50, s49, 6
s_sub_u32 s50, s48, s50
s_mul_i32 s49, s49, 40
s_add_u32 s49, s49, s44
s_mul_i32 s49, s49, 6
s_add_u32 s49, s49, s50
s_lshl_b32 s53, s49, 10
v_mov_b32 v4, s52
v_mov_b32 v5, s53
v_cndmask_b32 v4, v4, v5, vcc
v_add_u32 v4, v4, v6
buffer_store_dwordx4 v[56:59], v4, s[24:27], 0 offen sc1
s_lshl_b32 s48, s42, 4
s_add_u32 s48, s48, 1
s_mul_i32 s49, s48, 10923
s_lshr_b32 s49, s49, 16
s_mul_i32 s50, s49, 6
s_sub_u32 s50, s48, s50
s_mul_i32 s49, s49, 40
s_add_u32 s49, s49, s44
s_mul_i32 s49, s49, 6
s_add_u32 s49, s49, s50
s_lshl_b32 s52, s49, 10
s_lshl_b32 s48, s42, 4
s_add_u32 s48, s48, 9
s_mul_i32 s49, s48, 10923
s_lshr_b32 s49, s49, 16
s_mul_i32 s50, s49, 6
s_sub_u32 s50, s48, s50
s_mul_i32 s49, s49, 40
s_add_u32 s49, s49, s44
s_mul_i32 s49, s49, 6
s_add_u32 s49, s49, s50
s_lshl_b32 s53, s49, 10
v_mov_b32 v4, s52
v_mov_b32 v5, s53
v_cndmask_b32 v4, v4, v5, vcc
v_add_u32 v4, v4, v6
buffer_store_dwordx4 v[60:63], v4, s[24:27], 0 offen sc1
s_lshl_b32 s48, s42, 4
s_add_u32 s48, s48, 2
s_mul_i32 s49, s48, 10923
s_lshr_b32 s49, s49, 16
s_mul_i32 s50, s49, 6
s_sub_u32 s50, s48, s50
s_mul_i32 s49, s49, 40
s_add_u32 s49, s49, s44
s_mul_i32 s49, s49, 6
s_add_u32 s49, s49, s50
s_lshl_b32 s52, s49, 10
s_lshl_b32 s48, s42, 4
s_add_u32 s48, s48, 10
s_mul_i32 s49, s48, 10923
s_lshr_b32 s49, s49, 16
s_mul_i32 s50, s49, 6
s_sub_u32 s50, s48, s50
s_mul_i32 s49, s49, 40
s_add_u32 s49, s49, s44
s_mul_i32 s49, s49, 6
s_add_u32 s49, s49, s50
s_lshl_b32 s53, s49, 10
v_mov_b32 v4, s52
v_mov_b32 v5, s53
v_cndmask_b32 v4, v4, v5, vcc
v_add_u32 v4, v4, v6
buffer_store_dwordx4 v[64:67], v4, s[24:27], 0 offen sc1
s_lshl_b32 s48, s42, 4
s_add_u32 s48, s48, 3
s_mul_i32 s49, s48, 10923
s_lshr_b32 s49, s49, 16
s_mul_i32 s50, s49, 6
s_sub_u32 s50, s48, s50
s_mul_i32 s49, s49, 40
s_add_u32 s49, s49, s44
s_mul_i32 s49, s49, 6
s_add_u32 s49, s49, s50
s_lshl_b32 s52, s49, 10
s_lshl_b32 s48, s42, 4
s_add_u32 s48, s48, 11
s_mul_i32 s49, s48, 10923
s_lshr_b32 s49, s49, 16
s_mul_i32 s50, s49, 6
s_sub_u32 s50, s48, s50
s_mul_i32 s49, s49, 40
s_add_u32 s49, s49, s44
s_mul_i32 s49, s49, 6
s_add_u32 s49, s49, s50
s_lshl_b32 s53, s49, 10
v_mov_b32 v4, s52
v_mov_b32 v5, s53
v_cndmask_b32 v4, v4, v5, vcc
v_add_u32 v4, v4, v6
buffer_store_dwordx4 v[68:71], v4, s[24:27], 0 offen sc1
s_lshl_b32 s48, s42, 4
s_add_u32 s48, s48, 4
s_mul_i32 s49, s48, 10923
s_lshr_b32 s49, s49, 16
s_mul_i32 s50, s49, 6
s_sub_u32 s50, s48, s50
s_mul_i32 s49, s49, 40
s_add_u32 s49, s49, s44
s_mul_i32 s49, s49, 6
s_add_u32 s49, s49, s50
s_lshl_b32 s52, s49, 10
s_lshl_b32 s48, s42, 4
s_add_u32 s48, s48, 12
s_mul_i32 s49, s48, 10923
s_lshr_b32 s49, s49, 16
s_mul_i32 s50, s49, 6
s_sub_u32 s50, s48, s50
s_mul_i32 s49, s49, 40
s_add_u32 s49, s49, s44
s_mul_i32 s49, s49, 6
s_add_u32 s49, s49, s50
s_lshl_b32 s53, s49, 10
v_mov_b32 v4, s52
v_mov_b32 v5, s53
v_cndmask_b32 v4, v4, v5, vcc
v_add_u32 v4, v4, v6
buffer_store_dwordx4 v[72:75], v4, s[24:27], 0 offen sc1
s_lshl_b32 s48, s42, 4
s_add_u32 s48, s48, 5
s_mul_i32 s49, s48, 10923
s_lshr_b32 s49, s49, 16
s_mul_i32 s50, s49, 6
s_sub_u32 s50, s48, s50
s_mul_i32 s49, s49, 40
s_add_u32 s49, s49, s44
s_mul_i32 s49, s49, 6
s_add_u32 s49, s49, s50
s_lshl_b32 s52, s49, 10
s_lshl_b32 s48, s42, 4
s_add_u32 s48, s48, 13
s_mul_i32 s49, s48, 10923
s_lshr_b32 s49, s49, 16
s_mul_i32 s50, s49, 6
s_sub_u32 s50, s48, s50
s_mul_i32 s49, s49, 40
s_add_u32 s49, s49, s44
s_mul_i32 s49, s49, 6
s_add_u32 s49, s49, s50
s_lshl_b32 s53, s49, 10
v_mov_b32 v4, s52
v_mov_b32 v5, s53
v_cndmask_b32 v4, v4, v5, vcc
v_add_u32 v4, v4, v6
buffer_store_dwordx4 v[76:79], v4, s[24:27], 0 offen sc1
s_lshl_b32 s48, s42, 4
s_add_u32 s48, s48, 6
s_mul_i32 s49, s48, 10923
s_lshr_b32 s49, s49, 16
s_mul_i32 s50, s49, 6
s_sub_u32 s50, s48, s50
s_mul_i32 s49, s49, 40
s_add_u32 s49, s49, s44
s_mul_i32 s49, s49, 6
s_add_u32 s49, s49, s50
s_lshl_b32 s52, s49, 10
s_lshl_b32 s48, s42, 4
s_add_u32 s48, s48, 14
s_mul_i32 s49, s48, 10923
s_lshr_b32 s49, s49, 16
s_mul_i32 s50, s49, 6
s_sub_u32 s50, s48, s50
s_mul_i32 s49, s49, 40
s_add_u32 s49, s49, s44
s_mul_i32 s49, s49, 6
s_add_u32 s49, s49, s50
s_lshl_b32 s53, s49, 10
v_mov_b32 v4, s52
v_mov_b32 v5, s53
v_cndmask_b32 v4, v4, v5, vcc
v_add_u32 v4, v4, v6
buffer_store_dwordx4 v[80:83], v4, s[24:27], 0 offen sc1
s_lshl_b32 s48, s42, 4
s_add_u32 s48, s48, 7
s_mul_i32 s49, s48, 10923
s_lshr_b32 s49, s49, 16
s_mul_i32 s50, s49, 6
s_sub_u32 s50, s48, s50
s_mul_i32 s49, s49, 40
s_add_u32 s49, s49, s44
s_mul_i32 s49, s49, 6
s_add_u32 s49, s49, s50
s_lshl_b32 s52, s49, 10
s_lshl_b32 s48, s42, 4
s_add_u32 s48, s48, 15
s_mul_i32 s49, s48, 10923
s_lshr_b32 s49, s49, 16
s_mul_i32 s50, s49, 6
s_sub_u32 s50, s48, s50
s_mul_i32 s49, s49, 40
s_add_u32 s49, s49, s44
s_mul_i32 s49, s49, 6
s_add_u32 s49, s49, s50
s_lshl_b32 s53, s49, 10
v_mov_b32 v4, s52
v_mov_b32 v5, s53
v_cndmask_b32 v4, v4, v5, vcc
v_add_u32 v4, v4, v6
buffer_store_dwordx4 v[84:87], v4, s[24:27], 0 offen sc1
s_lshl_b32 s48, s3, 12
v_lshlrev_b32 v5, 11, v3
v_lshl_add_u32 v5, v2, 6, v5
v_add_u32 v5, s48, v5
ds_write_b128 v5, v[88:91] offset:0
ds_write_b128 v5, v[92:95] offset:16
ds_write_b128 v5, v[96:99] offset:32
ds_write_b128 v5, v[100:103] offset:48
s_waitcnt lgkmcnt(0)
s_barrier
v_lshlrev_b32 v5, 3, v0
ds_read_b64 v[8:9], v5 offset:0
ds_read_b64 v[10:11], v5 offset:2048
ds_read_b64 v[12:13], v5 offset:4096
ds_read_b64 v[14:15], v5 offset:6144
ds_read_b64 v[16:17], v5 offset:8192
ds_read_b64 v[18:19], v5 offset:10240
ds_read_b64 v[20:21], v5 offset:12288
ds_read_b64 v[22:23], v5 offset:14336
v_and_b32 v24, 7, v0
v_lshrrev_b32 v26, 7, v0
v_lshl_add_u32 v24, v26, 3, v24
s_lshl_b32 s48, s42, 4
v_add_u32 v24, s48, v24
v_mul_u32_u24 v25, 10923, v24
v_lshrrev_b32 v25, 16, v25
v_mul_u32_u24 v26, 6, v25
v_sub_u32 v26, v24, v26
s_lshl_b32 s48, s43, 4
v_add_u32 v25, s48, v25
v_mul_u32_u24 v25, 192, v25
v_lshl_add_u32 v25, v26, 5, v25
v_bfe_u32 v26, v0, 3, 4
v_add_u32 v25, v25, v26
s_lshl_b32 s48, s40, 4
v_add_u32 v25, s48, v25
v_lshlrev_b32 v25, 3, v25
s_waitcnt lgkmcnt(0)
v_add_f32 v8, v8, v16
v_add_f32 v9, v9, v17
v_add_f32 v10, v10, v18
v_add_f32 v11, v11, v19
v_add_f32 v12, v12, v20
v_add_f32 v13, v13, v21
v_add_f32 v14, v14, v22
v_add_f32 v15, v15, v23
v_add_f32 v8, v8, v12
v_add_f32 v9, v9, v13
v_add_f32 v10, v10, v14
v_add_f32 v11, v11, v15
v_add_f32 v8, v8, v10
v_add_f32 v9, v9, v11
buffer_store_dwordx2 v[8:9], v25, s[28:31], 0 offen sc1
s_waitcnt vmcnt(0)
s_endpgm
k1_roleD:
v_lshrrev_b32 v1, 6, v0
s_nop 0
v_readfirstlane_b32 s3, v1
s_load_dwordx2 s[4:5], s[0:1], 80
s_load_dwordx2 s[14:15], s[0:1], 120
s_sub_u32 s40, s2, 760
s_lshr_b32 s41, s40, 1
s_and_b32 s42, s40, 1
s_lshr_b32 s43, s41, 2
s_lshl_b32 s43, s43, 7
s_lshl_b32 s44, s41, 1
s_and_b32 s44, s44, 7
s_add_u32 s43, s43, s44
s_mul_i32 s43, s43, 1280
s_mul_i32 s44, s42, 640
s_add_u32 s43, s43, s44
v_and_b32 v2, 63, v0
s_waitcnt lgkmcnt(0)
s_mov_b32 s16, s4
s_mov_b32 s17, s5
s_mov_b32 s18, 0x1e0000
s_mov_b32 s19, 0x20000
s_add_u32 s20, s14, 0xc00000
s_addc_u32 s21, s15, 0
s_mov_b32 s22, 0x1e0000
s_mov_b32 s23, 0x20000
s_lshl_b32 s45, s3, 6
s_add_u32 s45, s45, 0
v_add_u32 v3, s45, v2
v_mul_u32_u24 v4, 1561, v3
v_lshrrev_b32 v4, 16, v4
v_mul_u32_u24 v5, 42, v4
v_sub_u32 v5, v3, v5
v_and_b32 v6, 3, v4
v_bfe_u32 v7, v4, 2, 1
v_lshl_add_u32 v6, v7, 2, v6
v_bfe_u32 v7, v4, 4, 1
v_lshl_add_u32 v6, v7, 3, v6
v_bfe_u32 v7, v4, 3, 1
v_lshl_add_u32 v6, v6, 3, v7
v_mul_u32_u24 v6, 1280, v6
v_lshl_add_u32 v6, v5, 4, v6
v_cmp_gt_u32 vcc, 40, v5
v_mov_b32 v7, 0x7ff00000
s_lshl_b32 s46, s45, 4
v_cndmask_b32 v6, v7, v6, vcc
s_mov_b32 m0, s46
s_nop 0
buffer_load_dwordx4 v6, s[16:19], s43 offen lds
s_lshl_b32 s45, s3, 6
s_add_u32 s45, s45, 256
v_add_u32 v3, s45, v2
v_mul_u32_u24 v4, 1561, v3
v_lshrrev_b32 v4, 16, v4
v_mul_u32_u24 v5, 42, v4
v_sub_u32 v5, v3, v5
v_and_b32 v6, 3, v4
v_bfe_u32 v7, v4, 2, 1
v_lshl_add_u32 v6, v7, 2, v6
v_bfe_u32 v7, v4, 4, 1
v_lshl_add_u32 v6, v7, 3, v6
v_bfe_u32 v7, v4, 3, 1
v_lshl_add_u32 v6, v6, 3, v7
v_mul_u32_u24 v6, 1280, v6
v_lshl_add_u32 v6, v5, 4, v6
v_cmp_gt_u32 vcc, 40, v5
v_mov_b32 v7, 0x7ff00000
s_lshl_b32 s46, s45, 4
v_cndmask_b32 v6, v7, v6, vcc
s_mov_b32 m0, s46
s_nop 0
buffer_load_dwordx4 v6, s[16:19], s43 offen lds
s_lshl_b32 s45, s3, 6
s_add_u32 s45, s45, 512
v_add_u32 v3, s45, v2
v_mul_u32_u24 v4, 1561, v3
v_lshrrev_b32 v4, 16, v4
v_mul_u32_u24 v5, 42, v4
v_sub_u32 v5, v3, v5
v_and_b32 v6, 3, v4
v_bfe_u32 v7, v4, 2, 1
v_lshl_add_u32 v6, v7, 2, v6
v_bfe_u32 v7, v4, 4, 1
v_lshl_add_u32 v6, v7, 3, v6
v_bfe_u32 v7, v4, 3, 1
v_lshl_add_u32 v6, v6, 3, v7
v_mul_u32_u24 v6, 1280, v6
v_lshl_add_u32 v6, v5, 4, v6
v_cmp_gt_u32 vcc, 40, v5
v_mov_b32 v7, 0x7ff00000
s_lshl_b32 s46, s45, 4
v_cndmask_b32 v6, v7, v6, vcc
s_mov_b32 m0, s46
s_nop 0
buffer_load_dwordx4 v6, s[16:19], s43 offen lds
s_lshl_b32 s45, s3, 6
s_add_u32 s45, s45, 768
v_add_u32 v3, s45, v2
v_mul_u32_u24 v4, 1561, v3
v_lshrrev_b32 v4, 16, v4
v_mul_u32_u24 v5, 42, v4
v_sub_u32 v5, v3, v5
v_and_b32 v6, 3, v4
v_bfe_u32 v7, v4, 2, 1
v_lshl_add_u32 v6, v7, 2, v6
v_bfe_u32 v7, v4, 4, 1
v_lshl_add_u32 v6, v7, 3, v6
v_bfe_u32 v7, v4, 3, 1
v_lshl_add_u32 v6, v6, 3, v7
v_mul_u32_u24 v6, 1280, v6
v_lshl_add_u32 v6, v5, 4, v6
v_cmp_gt_u32 vcc, 40, v5
v_mov_b32 v7, 0x7ff00000
s_lshl_b32 s46, s45, 4
v_cndmask_b32 v6, v7, v6, vcc
s_mov_b32 m0, s46
s_nop 0
buffer_load_dwordx4 v6, s[16:19], s43 offen lds
s_lshl_b32 s45, s3, 6
s_add_u32 s45, s45, 1024
v_add_u32 v3, s45, v2
v_mul_u32_u24 v4, 1561, v3
v_lshrrev_b32 v4, 16, v4
v_mul_u32_u24 v5, 42, v4
v_sub_u32 v5, v3, v5
v_and_b32 v6, 3, v4
v_bfe_u32 v7, v4, 2, 1
v_lshl_add_u32 v6, v7, 2, v6
v_bfe_u32 v7, v4, 4, 1
v_lshl_add_u32 v6, v7, 3, v6
v_bfe_u32 v7, v4, 3, 1
v_lshl_add_u32 v6, v6, 3, v7
v_mul_u32_u24 v6, 1280, v6
v_lshl_add_u32 v6, v5, 4, v6
v_cmp_gt_u32 vcc, 40, v5
v_mov_b32 v7, 0x7ff00000
s_lshl_b32 s46, s45, 4
v_cndmask_b32 v6, v7, v6, vcc
s_mov_b32 m0, s46
s_nop 0
buffer_load_dwordx4 v6, s[16:19], s43 offen lds
s_cmp_lg_u32 s3, 0
s_cbranch_scc1 k1d_skip_11
s_lshl_b32 s45, s3, 6
s_add_u32 s45, s45, 1280
v_add_u32 v3, s45, v2
v_mul_u32_u24 v4, 1561, v3
v_lshrrev_b32 v4, 16, v4
v_mul_u32_u24 v5, 42, v4
v_sub_u32 v5, v3, v5
v_and_b32 v6, 3, v4
v_bfe_u32 v7, v4, 2, 1
v_lshl_add_u32 v6, v7, 2, v6
v_bfe_u32 v7, v4, 4, 1
v_lshl_add_u32 v6, v7, 3, v6
v_bfe_u32 v7, v4, 3, 1
v_lshl_add_u32 v6, v6, 3, v7
v_mul_u32_u24 v6, 1280, v6
v_lshl_add_u32 v6, v5, 4, v6
v_cmp_gt_u32 vcc, 40, v5
v_mov_b32 v7, 0x7ff00000
s_lshl_b32 s46, s45, 4
v_cndmask_b32 v6, v7, v6, vcc
s_mov_b32 m0, s46
s_nop 0
buffer_load_dwordx4 v6, s[16:19], s43 offen lds
k1d_skip_11:
v_lshrrev_b32 v3, 4, v2
v_bfe_u32 v4, v2, 2, 2
v_and_b32 v5, 3, v2
v_lshrrev_b32 v6, 1, v3
v_lshl_add_u32 v4, v6, 3, v4
v_and_b32 v6, 1, v3
v_lshl_add_u32 v4, v6, 2, v4
v_mul_u32_u24 v4, 672, v4
v_lshl_add_u32 v4, v5, 3, v4
s_mul_i32 s45, s3, 160
v_add_u32 v4, s45, v4
s_lshl_b32 s45, s42, 2
s_add_u32 s45, s45, s3
s_mul_i32 s45, s45, 48
s_add_u32 s45, s45, s41
s_mul_i32 s45, s45, 5120
v_lshlrev_b32 v5, 4, v2
v_add_u32 v5, s45, v5
s_movk_i32 s47, 4096
s_waitcnt vmcnt(0)
s_barrier
ds_read_b64_tr_b16 v[8:9], v4 offset:0
ds_read_b64_tr_b16 v[10:11], v4 offset:10752
ds_read_b64_tr_b16 v[12:13], v4 offset:32
ds_read_b64_tr_b16 v[14:15], v4 offset:10784
ds_read_b64_tr_b16 v[16:17], v4 offset:64
ds_read_b64_tr_b16 v[18:19], v4 offset:10816
ds_read_b64_tr_b16 v[20:21], v4 offset:96
ds_read_b64_tr_b16 v[22:23], v4 offset:10848
ds_read_b64_tr_b16 v[24:25], v4 offset:128
ds_read_b64_tr_b16 v[26:27], v4 offset:10880
s_waitcnt lgkmcnt(8)
buffer_store_dwordx4 v[8:11], v5, s[20:23], 0 offen offset:0 sc1
s_waitcnt lgkmcnt(6)
buffer_store_dwordx4 v[12:15], v5, s[20:23], 0 offen offset:1024 sc1
s_waitcnt lgkmcnt(4)
buffer_store_dwordx4 v[16:19], v5, s[20:23], 0 offen offset:2048 sc1
s_waitcnt lgkmcnt(2)
buffer_store_dwordx4 v[20:23], v5, s[20:23], 0 offen offset:3072 sc1
s_waitcnt lgkmcnt(0)
buffer_store_dwordx4 v[24:27], v5, s[20:23], s47 offen sc1
s_waitcnt vmcnt(0)
s_endpgm
.globl k34_kernel
.p2align 8
.type k34_kernel,@function
k34_kernel:
s_cmp_ge_u32 s2, 256
s_cbranch_scc1 k34_exit
v_lshrrev_b32 v1, 6, v0
s_nop 0
v_readfirstlane_b32 s3, v1
s_load_dwordx2 s[12:13], s[0:1], 104
s_load_dwordx2 s[14:15], s[0:1], 120
s_and_b32 s42, s2, 7
s_lshr_b32 s43, s2, 3
s_and_b32 s40, s42, 1
s_lshl_b32 s40, s40, 3
s_and_b32 s44, s43, 7
s_add_u32 s40, s40, s44
s_lshr_b32 s41, s42, 1
s_lshl_b32 s41, s41, 2
s_lshr_b32 s44, s43, 3
s_add_u32 s41, s41, s44
s_cmp_lt_u32 s3, 4
s_cbranch_scc0 k34_helper
s_waitcnt lgkmcnt(0)
s_add_u32 s16, s14, 0x500000
s_addc_u32 s17, s15, 0
s_mov_b32 s18, 0x280000
s_mov_b32 s19, 0x20000
s_add_u32 s28, s14, 0xe00000
s_addc_u32 s29, s15, 0
s_mov_b32 s30, 0x600000
s_mov_b32 s31, 0x20000
s_add_u32 s32, s14, 0x160000
s_addc_u32 s33, s15, 0
s_mov_b32 s34, 0x5000
s_mov_b32 s35, 0x20000
s_add_u32 s68, s14, 0x120000
s_addc_u32 s69, s15, 0
s_mov_b32 s70, 0x40000
s_mov_b32 s71, 0x20000
s_add_u32 s64, s14, 0x170000
s_addc_u32 s65, s15, 0
s_mov_b32 s66, 0x7800
s_mov_b32 s67, 0x20000
s_setprio 2
v_and_b32 v16, 63, v0
s_lshr_b32 s56, s3, 1
s_and_b32 s57, s3, 1
v_lshlrev_b32 v6, 4, v16
s_mul_i32 s44, s57, 3072
v_add_u32 v6, s44, v6
v_lshrrev_b32 v11, 5, v16
v_bfe_u32 v12, v16, 2, 2
v_lshl_add_u32 v13, v11, 3, v12
v_bfe_u32 v14, v16, 4, 1
v_bfe_u32 v15, v16, 1, 1
v_lshl_add_u32 v14, v14, 1, v15
s_lshl_b32 s44, s56, 3
v_add_u32 v14, s44, v14
v_lshlrev_b32 v15, 2, v12
v_xor_b32 v14, v14, v15
v_lshlrev_b32 v14, 4, v14
v_lshl_add_u32 v14, v13, 8, v14
v_and_b32 v15, 1, v16
v_lshl_add_u32 v5, v15, 3, v14
v_xor_b32 v7, 64, v5
v_mov_b32 v3, v5
v_mov_b32 v9, v7
v_mov_b32 v4, v6
v_min_u32 v17, 32, v16
v_lshlrev_b32 v17, 4, v17
s_mul_i32 s44, s57, 1584
s_add_u32 s44, s44, 143360
v_add_u32 v18, s44, v17
s_mul_i32 s44, s56, 1056
s_add_u32 s44, s44, 146528
v_add_u32 v17, s44, v17
v_and_b32 v19, 31, v16
v_lshlrev_b32 v19, 3, v19
s_lshl_b32 s44, s56, 9
s_add_u32 s44, s44, 148640
v_add_u32 v19, s44, v19
s_barrier
ds_read_b64_tr_b16 v[32:33], v3 offset:0
ds_read_b64_tr_b16 v[34:35], v3 offset:1024
ds_read_b128 v[20:23], v4 offset:8192
ds_read_b64_tr_b16 v[36:37], v9 offset:0
ds_read_b64_tr_b16 v[38:39], v9 offset:1024
ds_read_b128 v[24:27], v4 offset:9216
ds_read_b128 v[28:31], v4 offset:10240
v_mov_b32 v1, v3
v_mov_b32 v8, v9
v_mov_b32 v2, v4
s_mov_b32 s47, 20480
v_add_u32 v3, s47, v5
v_add_u32 v9, s47, v7
v_add_u32 v4, s47, v6
s_waitcnt lgkmcnt(0)
v_mfma_f32_32x32x16_bf16 v[64:79], v[20:23], v[32:35], 0
ds_read_b64_tr_b16 v[52:53], v1 offset:4096
ds_read_b64_tr_b16 v[54:55], v1 offset:5120
v_mfma_f32_32x32x16_bf16 v[80:95], v[20:23], v[36:39], 0
ds_read_b128 v[40:43], v2 offset:14336
ds_read_b64_tr_b16 v[56:57], v8 offset:4096
v_mfma_f32_32x32x16_bf16 v[96:111], v[24:27], v[32:35], 0
ds_read_b64_tr_b16 v[58:59], v8 offset:5120
ds_read_b128 v[44:47], v2 offset:15360
v_mfma_f32_32x32x16_bf16 v[112:127], v[24:27], v[36:39], 0
ds_read_b128 v[48:51], v2 offset:16384
v_mfma_f32_32x32x16_bf16 v[128:143], v[28:31], v[32:35], 0
v_mfma_f32_32x32x16_bf16 v[144:159], v[28:31], v[36:39], 0
s_waitcnt lgkmcnt(0)
v_mfma_f32_32x32x16_bf16 v[64:79], v[40:43], v[52:55], v[64:79]
ds_read_b64_tr_b16 v[32:33], v3 offset:0
ds_read_b64_tr_b16 v[34:35], v3 offset:1024
v_mfma_f32_32x32x16_bf16 v[80:95], v[40:43], v[56:59], v[80:95]
ds_read_b128 v[20:23], v4 offset:8192
ds_read_b64_tr_b16 v[36:37], v9 offset:0
v_mfma_f32_32x32x16_bf16 v[96:111], v[44:47], v[52:55], v[96:111]
ds_read_b64_tr_b16 v[38:39], v9 offset:1024
ds_read_b128 v[24:27], v4 offset:9216
v_mfma_f32_32x32x16_bf16 v[112:127], v[44:47], v[56:59], v[112:127]
ds_read_b128 v[28:31], v4 offset:10240
v_mov_b32 v1, v3
v_mfma_f32_32x32x16_bf16 v[128:143], v[48:51], v[52:55], v[128:143]
v_mov_b32 v8, v9
v_mov_b32 v2, v4
v_mfma_f32_32x32x16_bf16 v[144:159], v[48:51], v[56:59], v[144:159]
s_add_u32 s47, s47, 20480
s_cmp_eq_u32 s47, 143360
s_cselect_b32 s47, 0, s47
v_add_u32 v3, s47, v5
v_add_u32 v9, s47, v7
v_add_u32 v4, s47, v6
s_waitcnt lgkmcnt(0)
v_mfma_f32_32x32x16_bf16 v[64:79], v[20:23], v[32:35], v[64:79]
ds_read_b64_tr_b16 v[52:53], v1 offset:4096
ds_read_b64_tr_b16 v[54:55], v1 offset:5120
v_mfma_f32_32x32x16_bf16 v[80:95], v[20:23], v[36:39], v[80:95]
ds_read_b128 v[40:43], v2 offset:14336
ds_read_b64_tr_b16 v[56:57], v8 offset:4096
v_mfma_f32_32x32x16_bf16 v[96:111], v[24:27], v[32:35], v[96:111]
ds_read_b64_tr_b16 v[58:59], v8 offset:5120
ds_read_b128 v[44:47], v2 offset:15360
v_mfma_f32_32x32x16_bf16 v[112:127], v[24:27], v[36:39], v[112:127]
ds_read_b128 v[48:51], v2 offset:16384
v_mfma_f32_32x32x16_bf16 v[128:143], v[28:31], v[32:35], v[128:143]
v_mfma_f32_32x32x16_bf16 v[144:159], v[28:31], v[36:39], v[144:159]
s_waitcnt lgkmcnt(0)
s_barrier
v_mfma_f32_32x32x16_bf16 v[64:79], v[40:43], v[52:55], v[64:79]
ds_read_b64_tr_b16 v[32:33], v3 offset:0
ds_read_b64_tr_b16 v[34:35], v3 offset:1024
v_mfma_f32_32x32x16_bf16 v[80:95], v[40:43], v[56:59], v[80:95]
ds_read_b128 v[20:23], v4 offset:8192
ds_read_b64_tr_b16 v[36:37], v9 offset:0
v_mfma_f32_32x32x16_bf16 v[96:111], v[44:47], v[52:55], v[96:111]
ds_read_b64_tr_b16 v[38:39], v9 offset:1024
ds_read_b128 v[24:27], v4 offset:9216
v_mfma_f32_32x32x16_bf16 v[112:127], v[44:47], v[56:59], v[112:127]
ds_read_b128 v[28:31], v4 offset:10240
v_mov_b32 v1, v3
v_mfma_f32_32x32x16_bf16 v[128:143], v[48:51], v[52:55], v[128:143]
v_mov_b32 v8, v9
v_mov_b32 v2, v4
v_mfma_f32_32x32x16_bf16 v[144:159], v[48:51], v[56:59], v[144:159]
s_add_u32 s47, s47, 20480
s_cmp_eq_u32 s47, 143360
s_cselect_b32 s47, 0, s47
v_add_u32 v3, s47, v5
v_add_u32 v9, s47, v7
v_add_u32 v4, s47, v6
s_mov_b32 s48, 8
k34_mloop:
s_waitcnt lgkmcnt(0)
s_barrier
v_mfma_f32_32x32x16_bf16 v[64:79], v[20:23], v[32:35], v[64:79]
ds_read_b64_tr_b16 v[52:53], v1 offset:4096
ds_read_b64_tr_b16 v[54:55], v1 offset:5120
v_mfma_f32_32x32x16_bf16 v[80:95], v[20:23], v[36:39], v[80:95]
ds_read_b128 v[40:43], v2 offset:14336
ds_read_b64_tr_b16 v[56:57], v8 offset:4096
v_mfma_f32_32x32x16_bf16 v[96:111], v[24:27], v[32:35], v[96:111]
ds_read_b64_tr_b16 v[58:59], v8 offset:5120
ds_read_b128 v[44:47], v2 offset:15360
v_mfma_f32_32x32x16_bf16 v[112:127], v[24:27], v[36:39], v[112:127]
ds_read_b128 v[48:51], v2 offset:16384
v_mfma_f32_32x32x16_bf16 v[128:143], v[28:31], v[32:35], v[128:143]
v_mfma_f32_32x32x16_bf16 v[144:159], v[28:31], v[36:39], v[144:159]
s_waitcnt lgkmcnt(0)
v_mfma_f32_32x32x16_bf16 v[64:79], v[40:43], v[52:55], v[64:79]
ds_read_b64_tr_b16 v[32:33], v3 offset:0
ds_read_b64_tr_b16 v[34:35], v3 offset:1024
v_mfma_f32_32x32x16_bf16 v[80:95], v[40:43], v[56:59], v[80:95]
ds_read_b128 v[20:23], v4 offset:8192
ds_read_b64_tr_b16 v[36:37], v9 offset:0
v_mfma_f32_32x32x16_bf16 v[96:111], v[44:47], v[52:55], v[96:111]
ds_read_b64_tr_b16 v[38:39], v9 offset:1024
ds_read_b128 v[24:27], v4 offset:9216
v_mfma_f32_32x32x16_bf16 v[112:127], v[44:47], v[56:59], v[112:127]
ds_read_b128 v[28:31], v4 offset:10240
v_mov_b32 v1, v3
v_mfma_f32_32x32x16_bf16 v[128:143], v[48:51], v[52:55], v[128:143]
v_mov_b32 v8, v9
v_mov_b32 v2, v4
v_mfma_f32_32x32x16_bf16 v[144:159], v[48:51], v[56:59], v[144:159]
s_add_u32 s47, s47, 20480
s_cmp_eq_u32 s47, 143360
s_cselect_b32 s47, 0, s47
v_add_u32 v3, s47, v5
v_add_u32 v9, s47, v7
v_add_u32 v4, s47, v6
s_waitcnt lgkmcnt(0)
v_mfma_f32_32x32x16_bf16 v[64:79], v[20:23], v[32:35], v[64:79]
ds_read_b64_tr_b16 v[52:53], v1 offset:4096
ds_read_b64_tr_b16 v[54:55], v1 offset:5120
v_mfma_f32_32x32x16_bf16 v[80:95], v[20:23], v[36:39], v[80:95]
ds_read_b128 v[40:43], v2 offset:14336
ds_read_b64_tr_b16 v[56:57], v8 offset:4096
v_mfma_f32_32x32x16_bf16 v[96:111], v[24:27], v[32:35], v[96:111]
ds_read_b64_tr_b16 v[58:59], v8 offset:5120
ds_read_b128 v[44:47], v2 offset:15360
v_mfma_f32_32x32x16_bf16 v[112:127], v[24:27], v[36:39], v[112:127]
ds_read_b128 v[48:51], v2 offset:16384
v_mfma_f32_32x32x16_bf16 v[128:143], v[28:31], v[32:35], v[128:143]
v_mfma_f32_32x32x16_bf16 v[144:159], v[28:31], v[36:39], v[144:159]
s_waitcnt lgkmcnt(0)
v_mfma_f32_32x32x16_bf16 v[64:79], v[40:43], v[52:55], v[64:79]
ds_read_b64_tr_b16 v[32:33], v3 offset:0
ds_read_b64_tr_b16 v[34:35], v3 offset:1024
v_mfma_f32_32x32x16_bf16 v[80:95], v[40:43], v[56:59], v[80:95]
ds_read_b128 v[20:23], v4 offset:8192
ds_read_b64_tr_b16 v[36:37], v9 offset:0
v_mfma_f32_32x32x16_bf16 v[96:111], v[44:47], v[52:55], v[96:111]
ds_read_b64_tr_b16 v[38:39], v9 offset:1024
ds_read_b128 v[24:27], v4 offset:9216
v_mfma_f32_32x32x16_bf16 v[112:127], v[44:47], v[56:59], v[112:127]
ds_read_b128 v[28:31], v4 offset:10240
v_mov_b32 v1, v3
v_mfma_f32_32x32x16_bf16 v[128:143], v[48:51], v[52:55], v[128:143]
v_mov_b32 v8, v9
v_mov_b32 v2, v4
v_mfma_f32_32x32x16_bf16 v[144:159], v[48:51], v[56:59], v[144:159]
s_add_u32 s47, s47, 20480
s_cmp_eq_u32 s47, 143360
s_cselect_b32 s47, 0, s47
v_add_u32 v3, s47, v5
v_add_u32 v9, s47, v7
v_add_u32 v4, s47, v6
s_sub_u32 s48, s48, 1
s_cmp_lg_u32 s48, 0
s_cbranch_scc1 k34_mloop
s_waitcnt lgkmcnt(0)
s_barrier
v_mfma_f32_32x32x16_bf16 v[64:79], v[20:23], v[32:35], v[64:79]
ds_read_b64_tr_b16 v[52:53], v1 offset:4096
ds_read_b64_tr_b16 v[54:55], v1 offset:5120
v_mfma_f32_32x32x16_bf16 v[80:95], v[20:23], v[36:39], v[80:95]
ds_read_b128 v[40:43], v2 offset:14336
ds_read_b64_tr_b16 v[56:57], v8 offset:4096
v_mfma_f32_32x32x16_bf16 v[96:111], v[24:27], v[32:35], v[96:111]
ds_read_b64_tr_b16 v[58:59], v8 offset:5120
ds_read_b128 v[44:47], v2 offset:15360
v_mfma_f32_32x32x16_bf16 v[112:127], v[24:27], v[36:39], v[112:127]
ds_read_b128 v[48:51], v2 offset:16384
v_mfma_f32_32x32x16_bf16 v[128:143], v[28:31], v[32:35], v[128:143]
v_mfma_f32_32x32x16_bf16 v[144:159], v[28:31], v[36:39], v[144:159]
s_waitcnt lgkmcnt(0)
v_mfma_f32_32x32x16_bf16 v[64:79], v[40:43], v[52:55], v[64:79]
ds_read_b64_tr_b16 v[32:33], v3 offset:0
ds_read_b64_tr_b16 v[34:35], v3 offset:1024
v_mfma_f32_32x32x16_bf16 v[80:95], v[40:43], v[56:59], v[80:95]
ds_read_b128 v[20:23], v4 offset:8192
ds_read_b64_tr_b16 v[36:37], v9 offset:0
v_mfma_f32_32x32x16_bf16 v[96:111], v[44:47], v[52:55], v[96:111]
ds_read_b64_tr_b16 v[38:39], v9 offset:1024
ds_read_b128 v[24:27], v4 offset:9216
v_mfma_f32_32x32x16_bf16 v[112:127], v[44:47], v[56:59], v[112:127]
ds_read_b128 v[28:31], v4 offset:10240
v_mov_b32 v1, v3
v_mfma_f32_32x32x16_bf16 v[128:143], v[48:51], v[52:55], v[128:143]
v_mov_b32 v8, v9
v_mov_b32 v2, v4
v_mfma_f32_32x32x16_bf16 v[144:159], v[48:51], v[56:59], v[144:159]
s_add_u32 s47, s47, 20480
s_cmp_eq_u32 s47, 143360
s_cselect_b32 s47, 0, s47
v_add_u32 v3, s47, v5
v_add_u32 v9, s47, v7
v_add_u32 v4, s47, v6
s_waitcnt lgkmcnt(0)
v_mfma_f32_32x32x16_bf16 v[64:79], v[20:23], v[32:35], v[64:79]
ds_read_b64_tr_b16 v[52:53], v1 offset:4096
ds_read_b64_tr_b16 v[54:55], v1 offset:5120
v_mfma_f32_32x32x16_bf16 v[80:95], v[20:23], v[36:39], v[80:95]
ds_read_b128 v[40:43], v2 offset:14336
ds_read_b64_tr_b16 v[56:57], v8 offset:4096
v_mfma_f32_32x32x16_bf16 v[96:111], v[24:27], v[32:35], v[96:111]
ds_read_b64_tr_b16 v[58:59], v8 offset:5120
ds_read_b128 v[44:47], v2 offset:15360
v_mfma_f32_32x32x16_bf16 v[112:127], v[24:27], v[36:39], v[112:127]
ds_read_b128 v[48:51], v2 offset:16384
v_mfma_f32_32x32x16_bf16 v[128:143], v[28:31], v[32:35], v[128:143]
v_mfma_f32_32x32x16_bf16 v[144:159], v[28:31], v[36:39], v[144:159]
s_waitcnt lgkmcnt(0)
v_mfma_f32_32x32x16_bf16 v[64:79], v[40:43], v[52:55], v[64:79]
ds_read_b128 v[32:35], v17 offset:0
ds_read_b128 v[36:39], v17 offset:528
v_mfma_f32_32x32x16_bf16 v[80:95], v[40:43], v[56:59], v[80:95]
ds_read_b128 v[20:23], v18 offset:0
ds_read_b128 v[24:27], v18 offset:528
v_mfma_f32_32x32x16_bf16 v[96:111], v[44:47], v[52:55], v[96:111]
ds_read_b128 v[28:31], v18 offset:1056
ds_read_b64 v[10:11], v19
v_mfma_f32_32x32x16_bf16 v[112:127], v[44:47], v[56:59], v[112:127]
ds_read_b64 v[12:13], v19 offset:256
v_mfma_f32_32x32x16_bf16 v[128:143], v[48:51], v[52:55], v[128:143]
v_mfma_f32_32x32x16_bf16 v[144:159], v[48:51], v[56:59], v[144:159]
v_bfe_u32 v2, v16, 4, 1
v_lshlrev_b32 v2, 10, v2
v_lshrrev_b32 v9, 5, v16
v_lshl_add_u32 v2, v9, 8, v2
v_and_b32 v3, 15, v16
v_lshl_add_u32 v2, v3, 4, v2
s_lshl_b32 s44, s40, 1
s_add_u32 s44, s44, s56
s_mul_i32 s44, s44, 196608
s_mul_i32 s45, s41, 6
s_mul_i32 s46, s57, 3
s_add_u32 s45, s45, s46
s_waitcnt lgkmcnt(0)
v_mfma_f32_32x32x16_bf16 v[64:79], v[20:23], v[32:35], v[64:79]
v_mfma_f32_32x32x16_bf16 v[80:95], v[20:23], v[36:39], v[80:95]
v_mfma_f32_32x32x16_bf16 v[96:111], v[24:27], v[32:35], v[96:111]
v_mfma_f32_32x32x16_bf16 v[112:127], v[24:27], v[36:39], v[112:127]
v_mfma_f32_32x32x16_bf16 v[128:143], v[28:31], v[32:35], v[128:143]
v_mfma_f32_32x32x16_bf16 v[144:159], v[28:31], v[36:39], v[144:159]
v_mul_f32 v4, 0xc0135761, v10
v_mul_f32 v6, v10, v10
v_mov_b32 v8, v11
v_mul_f32 v6, v6, v10
v_mul_f32 v6, 0xbdd2d3e8, v6
v_mul_f32 v14, 0xc0135761, v12
v_mul_f32 v16, v12, v12
v_mov_b32 v18, v13
v_mul_f32 v16, v16, v12
v_mul_f32 v16, 0xbdd2d3e8, v16
s_nop 7
s_add_u32 s46, s45, 0
s_lshr_b32 s47, s46, 1
s_lshl_b32 s47, s47, 12
s_and_b32 s46, s46, 1
s_lshl_b32 s46, s46, 9
s_add_u32 s47, s47, s46
s_add_u32 s47, s47, s44
v_pk_mul_f32 v[20:21], v[64:65], v[64:65]
v_pk_mul_f32 v[22:23], v[66:67], v[66:67]
v_pk_mul_f32 v[24:25], v[68:69], v[68:69]
v_pk_mul_f32 v[26:27], v[70:71], v[70:71]
v_pk_fma_f32 v[20:21], v[20:21], v[6:7], v[4:5] op_sel_hi:[1,0,0]
v_pk_fma_f32 v[22:23], v[22:23], v[6:7], v[4:5] op_sel_hi:[1,0,0]
v_pk_fma_f32 v[24:25], v[24:25], v[6:7], v[4:5] op_sel_hi:[1,0,0]
v_pk_fma_f32 v[26:27], v[26:27], v[6:7], v[4:5] op_sel_hi:[1,0,0]
v_pk_mul_f32 v[20:21], v[64:65], v[20:21]
v_pk_mul_f32 v[22:23], v[66:67], v[22:23]
v_pk_mul_f32 v[24:25], v[68:69], v[24:25]
v_pk_mul_f32 v[26:27], v[70:71], v[26:27]
v_exp_f32 v20, v20
v_exp_f32 v21, v21
v_exp_f32 v22, v22
v_exp_f32 v23, v23
v_exp_f32 v24, v24
v_exp_f32 v25, v25
v_exp_f32 v26, v26
v_exp_f32 v27, v27
v_pk_mul_f32 v[64:65], v[64:65], v[72:73]
v_pk_mul_f32 v[66:67], v[66:67], v[74:75]
v_pk_mul_f32 v[68:69], v[68:69], v[76:77]
v_pk_mul_f32 v[70:71], v[70:71], v[78:79]
v_pk_fma_f32 v[20:21], v[20:21], v[8:9], v[8:9] op_sel_hi:[1,0,0]
v_pk_fma_f32 v[22:23], v[22:23], v[8:9], v[8:9] op_sel_hi:[1,0,0]
v_pk_fma_f32 v[24:25], v[24:25], v[8:9], v[8:9] op_sel_hi:[1,0,0]
v_pk_fma_f32 v[26:27], v[26:27], v[8:9], v[8:9] op_sel_hi:[1,0,0]
v_rcp_f32 v20, v20
v_rcp_f32 v21, v21
v_rcp_f32 v22, v22
v_rcp_f32 v23, v23
v_rcp_f32 v24, v24
v_rcp_f32 v25, v25
v_rcp_f32 v26, v26
v_rcp_f32 v27, v27
s_nop 0
v_pk_mul_f32 v[64:65], v[64:65], v[20:21]
v_pk_mul_f32 v[66:67], v[66:67], v[22:23]
v_pk_mul_f32 v[68:69], v[68:69], v[24:25]
v_pk_mul_f32 v[70:71], v[70:71], v[26:27]
v_cvt_pk_bf16_f32 v28, v64, v65
v_cvt_pk_bf16_f32 v29, v66, v67
v_cvt_pk_bf16_f32 v30, v68, v69
v_cvt_pk_bf16_f32 v31, v70, v71
buffer_store_dwordx4 v[28:31], v2, s[28:31], s47 offen offset:0 sc1
v_pk_mul_f32 v[20:21], v[80:81], v[80:81]
v_pk_mul_f32 v[22:23], v[82:83], v[82:83]
v_pk_mul_f32 v[24:25], v[84:85], v[84:85]
v_pk_mul_f32 v[26:27], v[86:87], v[86:87]
v_pk_fma_f32 v[20:21], v[20:21], v[16:17], v[14:15] op_sel_hi:[1,0,0]
v_pk_fma_f32 v[22:23], v[22:23], v[16:17], v[14:15] op_sel_hi:[1,0,0]
v_pk_fma_f32 v[24:25], v[24:25], v[16:17], v[14:15] op_sel_hi:[1,0,0]
v_pk_fma_f32 v[26:27], v[26:27], v[16:17], v[14:15] op_sel_hi:[1,0,0]
v_pk_mul_f32 v[20:21], v[80:81], v[20:21]
v_pk_mul_f32 v[22:23], v[82:83], v[22:23]
v_pk_mul_f32 v[24:25], v[84:85], v[24:25]
v_pk_mul_f32 v[26:27], v[86:87], v[26:27]
v_exp_f32 v20, v20
v_exp_f32 v21, v21
v_exp_f32 v22, v22
v_exp_f32 v23, v23
v_exp_f32 v24, v24
v_exp_f32 v25, v25
v_exp_f32 v26, v26
v_exp_f32 v27, v27
v_pk_mul_f32 v[80:81], v[80:81], v[88:89]
v_pk_mul_f32 v[82:83], v[82:83], v[90:91]
v_pk_mul_f32 v[84:85], v[84:85], v[92:93]
v_pk_mul_f32 v[86:87], v[86:87], v[94:95]
v_pk_fma_f32 v[20:21], v[20:21], v[18:19], v[18:19] op_sel_hi:[1,0,0]
v_pk_fma_f32 v[22:23], v[22:23], v[18:19], v[18:19] op_sel_hi:[1,0,0]
v_pk_fma_f32 v[24:25], v[24:25], v[18:19], v[18:19] op_sel_hi:[1,0,0]
v_pk_fma_f32 v[26:27], v[26:27], v[18:19], v[18:19] op_sel_hi:[1,0,0]
v_rcp_f32 v20, v20
v_rcp_f32 v21, v21
v_rcp_f32 v22, v22
v_rcp_f32 v23, v23
v_rcp_f32 v24, v24
v_rcp_f32 v25, v25
v_rcp_f32 v26, v26
v_rcp_f32 v27, v27
s_nop 0
v_pk_mul_f32 v[80:81], v[80:81], v[20:21]
v_pk_mul_f32 v[82:83], v[82:83], v[22:23]
v_pk_mul_f32 v[84:85], v[84:85], v[24:25]
v_pk_mul_f32 v[86:87], v[86:87], v[26:27]
v_cvt_pk_bf16_f32 v32, v80, v81
v_cvt_pk_bf16_f32 v33, v82, v83
v_cvt_pk_bf16_f32 v34, v84, v85
v_cvt_pk_bf16_f32 v35, v86, v87
buffer_store_dwordx4 v[32:35], v2, s[28:31], s47 offen offset:2048 sc1
s_add_u32 s46, s45, 1
s_lshr_b32 s47, s46, 1
s_lshl_b32 s47, s47, 12
s_and_b32 s46, s46, 1
s_lshl_b32 s46, s46, 9
s_add_u32 s47, s47, s46
s_add_u32 s47, s47, s44
v_pk_mul_f32 v[20:21], v[96:97], v[96:97]
v_pk_mul_f32 v[22:23], v[98:99], v[98:99]
v_pk_mul_f32 v[24:25], v[100:101], v[100:101]
v_pk_mul_f32 v[26:27], v[102:103], v[102:103]
v_pk_fma_f32 v[20:21], v[20:21], v[6:7], v[4:5] op_sel_hi:[1,0,0]
v_pk_fma_f32 v[22:23], v[22:23], v[6:7], v[4:5] op_sel_hi:[1,0,0]
v_pk_fma_f32 v[24:25], v[24:25], v[6:7], v[4:5] op_sel_hi:[1,0,0]
v_pk_fma_f32 v[26:27], v[26:27], v[6:7], v[4:5] op_sel_hi:[1,0,0]
v_pk_mul_f32 v[20:21], v[96:97], v[20:21]
v_pk_mul_f32 v[22:23], v[98:99], v[22:23]
v_pk_mul_f32 v[24:25], v[100:101], v[24:25]
v_pk_mul_f32 v[26:27], v[102:103], v[26:27]
v_exp_f32 v20, v20
v_exp_f32 v21, v21
v_exp_f32 v22, v22
v_exp_f32 v23, v23
v_exp_f32 v24, v24
v_exp_f32 v25, v25
v_exp_f32 v26, v26
v_exp_f32 v27, v27
v_pk_mul_f32 v[96:97], v[96:97], v[104:105]
v_pk_mul_f32 v[98:99], v[98:99], v[106:107]
v_pk_mul_f32 v[100:101], v[100:101], v[108:109]
v_pk_mul_f32 v[102:103], v[102:103], v[110:111]
v_pk_fma_f32 v[20:21], v[20:21], v[8:9], v[8:9] op_sel_hi:[1,0,0]
v_pk_fma_f32 v[22:23], v[22:23], v[8:9], v[8:9] op_sel_hi:[1,0,0]
v_pk_fma_f32 v[24:25], v[24:25], v[8:9], v[8:9] op_sel_hi:[1,0,0]
v_pk_fma_f32 v[26:27], v[26:27], v[8:9], v[8:9] op_sel_hi:[1,0,0]
v_rcp_f32 v20, v20
v_rcp_f32 v21, v21
v_rcp_f32 v22, v22
v_rcp_f32 v23, v23
v_rcp_f32 v24, v24
v_rcp_f32 v25, v25
v_rcp_f32 v26, v26
v_rcp_f32 v27, v27
s_nop 0
v_pk_mul_f32 v[96:97], v[96:97], v[20:21]
v_pk_mul_f32 v[98:99], v[98:99], v[22:23]
v_pk_mul_f32 v[100:101], v[100:101], v[24:25]
v_pk_mul_f32 v[102:103], v[102:103], v[26:27]
v_cvt_pk_bf16_f32 v36, v96, v97
v_cvt_pk_bf16_f32 v37, v98, v99
v_cvt_pk_bf16_f32 v38, v100, v101
v_cvt_pk_bf16_f32 v39, v102, v103
buffer_store_dwordx4 v[36:39], v2, s[28:31], s47 offen offset:0 sc1
v_pk_mul_f32 v[20:21], v[112:113], v[112:113]
v_pk_mul_f32 v[22:23], v[114:115], v[114:115]
v_pk_mul_f32 v[24:25], v[116:117], v[116:117]
v_pk_mul_f32 v[26:27], v[118:119], v[118:119]
v_pk_fma_f32 v[20:21], v[20:21], v[16:17], v[14:15] op_sel_hi:[1,0,0]
v_pk_fma_f32 v[22:23], v[22:23], v[16:17], v[14:15] op_sel_hi:[1,0,0]
v_pk_fma_f32 v[24:25], v[24:25], v[16:17], v[14:15] op_sel_hi:[1,0,0]
v_pk_fma_f32 v[26:27], v[26:27], v[16:17], v[14:15] op_sel_hi:[1,0,0]
v_pk_mul_f32 v[20:21], v[112:113], v[20:21]
v_pk_mul_f32 v[22:23], v[114:115], v[22:23]
v_pk_mul_f32 v[24:25], v[116:117], v[24:25]
v_pk_mul_f32 v[26:27], v[118:119], v[26:27]
v_exp_f32 v20, v20
v_exp_f32 v21, v21
v_exp_f32 v22, v22
v_exp_f32 v23, v23
v_exp_f32 v24, v24
v_exp_f32 v25, v25
v_exp_f32 v26, v26
v_exp_f32 v27, v27
v_pk_mul_f32 v[112:113], v[112:113], v[120:121]
v_pk_mul_f32 v[114:115], v[114:115], v[122:123]
v_pk_mul_f32 v[116:117], v[116:117], v[124:125]
v_pk_mul_f32 v[118:119], v[118:119], v[126:127]
v_pk_fma_f32 v[20:21], v[20:21], v[18:19], v[18:19] op_sel_hi:[1,0,0]
v_pk_fma_f32 v[22:23], v[22:23], v[18:19], v[18:19] op_sel_hi:[1,0,0]
v_pk_fma_f32 v[24:25], v[24:25], v[18:19], v[18:19] op_sel_hi:[1,0,0]
v_pk_fma_f32 v[26:27], v[26:27], v[18:19], v[18:19] op_sel_hi:[1,0,0]
v_rcp_f32 v20, v20
v_rcp_f32 v21, v21
v_rcp_f32 v22, v22
v_rcp_f32 v23, v23
v_rcp_f32 v24, v24
v_rcp_f32 v25, v25
v_rcp_f32 v26, v26
v_rcp_f32 v27, v27
s_nop 0
v_pk_mul_f32 v[112:113], v[112:113], v[20:21]
v_pk_mul_f32 v[114:115], v[114:115], v[22:23]
v_pk_mul_f32 v[116:117], v[116:117], v[24:25]
v_pk_mul_f32 v[118:119], v[118:119], v[26:27]
v_cvt_pk_bf16_f32 v40, v112, v113
v_cvt_pk_bf16_f32 v41, v114, v115
v_cvt_pk_bf16_f32 v42, v116, v117
v_cvt_pk_bf16_f32 v43, v118, v119
buffer_store_dwordx4 v[40:43], v2, s[28:31], s47 offen offset:2048 sc1
s_add_u32 s46, s45, 2
s_lshr_b32 s47, s46, 1
s_lshl_b32 s47, s47, 12
s_and_b32 s46, s46, 1
s_lshl_b32 s46, s46, 9
s_add_u32 s47, s47, s46
s_add_u32 s47, s47, s44
v_pk_mul_f32 v[20:21], v[128:129], v[128:129]
v_pk_mul_f32 v[22:23], v[130:131], v[130:131]
v_pk_mul_f32 v[24:25], v[132:133], v[132:133]
v_pk_mul_f32 v[26:27], v[134:135], v[134:135]
v_pk_fma_f32 v[20:21], v[20:21], v[6:7], v[4:5] op_sel_hi:[1,0,0]
v_pk_fma_f32 v[22:23], v[22:23], v[6:7], v[4:5] op_sel_hi:[1,0,0]
v_pk_fma_f32 v[24:25], v[24:25], v[6:7], v[4:5] op_sel_hi:[1,0,0]
v_pk_fma_f32 v[26:27], v[26:27], v[6:7], v[4:5] op_sel_hi:[1,0,0]
v_pk_mul_f32 v[20:21], v[128:129], v[20:21]
v_pk_mul_f32 v[22:23], v[130:131], v[22:23]
v_pk_mul_f32 v[24:25], v[132:133], v[24:25]
v_pk_mul_f32 v[26:27], v[134:135], v[26:27]
v_exp_f32 v20, v20
v_exp_f32 v21, v21
v_exp_f32 v22, v22
v_exp_f32 v23, v23
v_exp_f32 v24, v24
v_exp_f32 v25, v25
v_exp_f32 v26, v26
v_exp_f32 v27, v27
v_pk_mul_f32 v[128:129], v[128:129], v[136:137]
v_pk_mul_f32 v[130:131], v[130:131], v[138:139]
v_pk_mul_f32 v[132:133], v[132:133], v[140:141]
v_pk_mul_f32 v[134:135], v[134:135], v[142:143]
v_pk_fma_f32 v[20:21], v[20:21], v[8:9], v[8:9] op_sel_hi:[1,0,0]
v_pk_fma_f32 v[22:23], v[22:23], v[8:9], v[8:9] op_sel_hi:[1,0,0]
v_pk_fma_f32 v[24:25], v[24:25], v[8:9], v[8:9] op_sel_hi:[1,0,0]
v_pk_fma_f32 v[26:27], v[26:27], v[8:9], v[8:9] op_sel_hi:[1,0,0]
v_rcp_f32 v20, v20
v_rcp_f32 v21, v21
v_rcp_f32 v22, v22
v_rcp_f32 v23, v23
v_rcp_f32 v24, v24
v_rcp_f32 v25, v25
v_rcp_f32 v26, v26
v_rcp_f32 v27, v27
s_nop 0
v_pk_mul_f32 v[128:129], v[128:129], v[20:21]
v_pk_mul_f32 v[130:131], v[130:131], v[22:23]
v_pk_mul_f32 v[132:133], v[132:133], v[24:25]
v_pk_mul_f32 v[134:135], v[134:135], v[26:27]
v_cvt_pk_bf16_f32 v44, v128, v129
v_cvt_pk_bf16_f32 v45, v130, v131
v_cvt_pk_bf16_f32 v46, v132, v133
v_cvt_pk_bf16_f32 v47, v134, v135
buffer_store_dwordx4 v[44:47], v2, s[28:31], s47 offen offset:0 sc1
v_pk_mul_f32 v[20:21], v[144:145], v[144:145]
v_pk_mul_f32 v[22:23], v[146:147], v[146:147]
v_pk_mul_f32 v[24:25], v[148:149], v[148:149]
v_pk_mul_f32 v[26:27], v[150:151], v[150:151]
v_pk_fma_f32 v[20:21], v[20:21], v[16:17], v[14:15] op_sel_hi:[1,0,0]
v_pk_fma_f32 v[22:23], v[22:23], v[16:17], v[14:15] op_sel_hi:[1,0,0]
v_pk_fma_f32 v[24:25], v[24:25], v[16:17], v[14:15] op_sel_hi:[1,0,0]
v_pk_fma_f32 v[26:27], v[26:27], v[16:17], v[14:15] op_sel_hi:[1,0,0]
v_pk_mul_f32 v[20:21], v[144:145], v[20:21]
v_pk_mul_f32 v[22:23], v[146:147], v[22:23]
v_pk_mul_f32 v[24:25], v[148:149], v[24:25]
v_pk_mul_f32 v[26:27], v[150:151], v[26:27]
v_exp_f32 v20, v20
v_exp_f32 v21, v21
v_exp_f32 v22, v22
v_exp_f32 v23, v23
v_exp_f32 v24, v24
v_exp_f32 v25, v25
v_exp_f32 v26, v26
v_exp_f32 v27, v27
v_pk_mul_f32 v[144:145], v[144:145], v[152:153]
v_pk_mul_f32 v[146:147], v[146:147], v[154:155]
v_pk_mul_f32 v[148:149], v[148:149], v[156:157]
v_pk_mul_f32 v[150:151], v[150:151], v[158:159]
v_pk_fma_f32 v[20:21], v[20:21], v[18:19], v[18:19] op_sel_hi:[1,0,0]
v_pk_fma_f32 v[22:23], v[22:23], v[18:19], v[18:19] op_sel_hi:[1,0,0]
v_pk_fma_f32 v[24:25], v[24:25], v[18:19], v[18:19] op_sel_hi:[1,0,0]
v_pk_fma_f32 v[26:27], v[26:27], v[18:19], v[18:19] op_sel_hi:[1,0,0]
v_rcp_f32 v20, v20
v_rcp_f32 v21, v21
v_rcp_f32 v22, v22
v_rcp_f32 v23, v23
v_rcp_f32 v24, v24
v_rcp_f32 v25, v25
v_rcp_f32 v26, v26
v_rcp_f32 v27, v27
s_nop 0
v_pk_mul_f32 v[144:145], v[144:145], v[20:21]
v_pk_mul_f32 v[146:147], v[146:147], v[22:23]
v_pk_mul_f32 v[148:149], v[148:149], v[24:25]
v_pk_mul_f32 v[150:151], v[150:151], v[26:27]
v_cvt_pk_bf16_f32 v48, v144, v145
v_cvt_pk_bf16_f32 v49, v146, v147
v_cvt_pk_bf16_f32 v50, v148, v149
v_cvt_pk_bf16_f32 v51, v150, v151
buffer_store_dwordx4 v[48:51], v2, s[28:31], s47 offen offset:2048 sc1
s_waitcnt vmcnt(0)
s_lshl_b32 s44, s40, 1
s_add_u32 s44, s44, s56
s_lshl_b32 s44, s44, 2
s_lshr_b32 s45, s41, 2
s_add_u32 s44, s44, s45
s_lshl_b32 s44, s44, 7
s_add_u32 s44, s44, 2048
s_mov_b64 exec, 1
v_mov_b32 v10, s44
v_mov_b32 v11, 1
buffer_atomic_add v11, v10, s[32:35], 0 offen sc1
s_mov_b64 exec, -1
s_barrier
v_and_b32 v9, 63, v0
v_lshrrev_b32 v2, 3, v9
v_lshlrev_b32 v2, 12, v2
v_and_b32 v3, 7, v9
v_lshl_add_u32 v2, v3, 4, v2
s_and_b32 s50, s41, 7
s_mul_i32 s50, s50, 80
s_lshl_b32 s51, s3, 3
s_add_u32 s50, s50, s51
s_lshl_b32 s50, s50, 12
s_lshr_b32 s51, s41, 3
s_lshl_b32 s52, s40, 1
s_add_u32 s51, s51, s52
s_lshl_b32 s51, s51, 7
s_add_u32 s50, s50, s51
s_lshl_b32 s51, s3, 10
s_add_u32 s51, s51, 149664
s_mov_b32 m0, s51
s_add_u32 s51, s51, 4096
buffer_load_dwordx4 v2, s[16:19], s50 offen lds
s_add_u32 s50, s50, 131072
s_mov_b32 m0, s51
s_add_u32 s51, s51, 4096
buffer_load_dwordx4 v2, s[16:19], s50 offen lds
s_add_u32 s50, s50, 131072
s_cmp_ge_u32 s3, 2
s_cbranch_scc1 k34_skip_14
s_mov_b32 m0, s51
s_add_u32 s51, s51, 4096
buffer_load_dwordx4 v2, s[16:19], s50 offen lds
s_add_u32 s50, s50, 131072
k34_skip_14:
v_cmp_gt_u32 vcc, 80, v0
s_and_saveexec_b64 s[52:53], vcc
s_cbranch_execz k34_nogb_15
v_lshlrev_b32 v4, 2, v0
s_and_b32 s50, s41, 7
s_mul_i32 s50, s50, 320
s_add_u32 s50, s50, 12800
buffer_load_dword v5, v4, s[64:67], s50 offen
s_add_u32 s50, s50, 15360
buffer_load_dword v6, v4, s[64:67], s50 offen
v_add_u32 v4, 148640, v4
s_waitcnt vmcnt(0)
v_add_f32 v5, v5, v6
v_cvt_pk_bf16_f32 v6, v5, v5
v_lshlrev_b32 v5, 16, v6
ds_write_b32 v4, v5
k34_nogb_15:
s_mov_b64 exec, s[52:53]
s_waitcnt vmcnt(0) lgkmcnt(0)
s_barrier
s_endpgm
k34_helper:
s_sub_u32 s58, s3, 4
v_and_b32 v9, 63, v0
v_lshrrev_b32 v10, 4, v9
v_and_b32 v11, 15, v9
v_lshlrev_b32 v4, 2, v10
v_xor_b32 v11, v11, v4
v_mov_b32 v3, v11
v_lshlrev_b32 v11, 4, v11
v_lshl_add_u32 v7, v10, 12, v11
v_lshlrev_b32 v8, 4, v9
s_mul_i32 s4, s41, 5
s_lshr_b32 s4, s4, 2
s_mul_i32 s5, s41, 40
s_lshl_b32 s53, s4, 5
s_sub_u32 s5, s5, s53
s_lshl_b32 s44, s58, 15
s_lshl_b32 s45, s40, 8
s_add_u32 s44, s44, s45
s_lshl_b32 s53, s4, 17
s_add_u32 s44, s44, s53
s_mul_i32 s45, s41, 245760
s_mul_i32 s46, s58, 3072
s_add_u32 s45, s45, s46
s_mul_i32 s53, s4, 12288
s_add_u32 s45, s45, s53
s_lshl_b32 s50, s58, 11
s_add_u32 s51, s46, 8192
s_mov_b32 s46, 0
s_lshl_b32 s53, s40, 7
v_mov_b32 v5, s53
v_mov_b32 v6, 0
s_waitcnt lgkmcnt(0)
s_add_u32 s16, s14, 0x500000
s_addc_u32 s17, s15, 0
s_mov_b32 s18, 0x280000
s_mov_b32 s19, 0x20000
s_add_u32 s20, s14, 0x800000
s_addc_u32 s21, s15, 0
s_mov_b32 s22, 0x3c0000
s_mov_b32 s23, 0x20000
s_add_u32 m0, s46, s50
s_add_u32 s49, s44, 16384
buffer_load_dwordx4 v7, s[16:19], s44 offen lds
s_add_u32 s52, s50, 1024
s_add_u32 m0, s46, s52
s_nop 0
buffer_load_dwordx4 v7, s[16:19], s49 offen lds
s_add_u32 m0, s46, s51
s_add_u32 s44, s44, 131072
buffer_load_dwordx4 v8, s[20:23], s45 offen lds
buffer_load_dwordx4 v8, s[20:23], s45 offen offset:1024 lds
buffer_load_dwordx4 v8, s[20:23], s45 offen offset:2048 lds
s_add_u32 s45, s45, 12288
s_add_u32 s4, s4, 1
s_cmp_eq_u32 s4, 20
s_cselect_b32 s4, 0, s4
s_cselect_b32 s49, 2621440, 0
s_cselect_b32 s52, 245760, 0
s_sub_u32 s44, s44, s49
s_sub_u32 s45, s45, s52
s_add_u32 s46, s46, 20480
s_cmp_eq_u32 s46, 143360
s_cselect_b32 s46, 0, s46
s_add_u32 m0, s46, s50
s_add_u32 s49, s44, 16384
buffer_load_dwordx4 v7, s[16:19], s44 offen lds
s_add_u32 s52, s50, 1024
s_add_u32 m0, s46, s52
s_nop 0
buffer_load_dwordx4 v7, s[16:19], s49 offen lds
s_add_u32 m0, s46, s51
s_add_u32 s44, s44, 131072
buffer_load_dwordx4 v8, s[20:23], s45 offen lds
buffer_load_dwordx4 v8, s[20:23], s45 offen offset:1024 lds
buffer_load_dwordx4 v8, s[20:23], s45 offen offset:2048 lds
s_add_u32 s45, s45, 12288
s_add_u32 s4, s4, 1
s_cmp_eq_u32 s4, 20
s_cselect_b32 s4, 0, s4
s_cselect_b32 s49, 2621440, 0
s_cselect_b32 s52, 245760, 0
s_sub_u32 s44, s44, s49
s_sub_u32 s45, s45, s52
s_add_u32 s46, s46, 20480
s_cmp_eq_u32 s46, 143360
s_cselect_b32 s46, 0, s46
s_add_u32 m0, s46, s50
s_add_u32 s49, s44, 16384
buffer_load_dwordx4 v7, s[16:19], s44 offen lds
s_add_u32 s52, s50, 1024
s_add_u32 m0, s46, s52
s_nop 0
buffer_load_dwordx4 v7, s[16:19], s49 offen lds
s_add_u32 m0, s46, s51
s_add_u32 s44, s44, 131072
buffer_load_dwordx4 v8, s[20:23], s45 offen lds
buffer_load_dwordx4 v8, s[20:23], s45 offen offset:1024 lds
buffer_load_dwordx4 v8, s[20:23], s45 offen offset:2048 lds
s_add_u32 s45, s45, 12288
s_add_u32 s4, s4, 1
s_cmp_eq_u32 s4, 20
s_cselect_b32 s4, 0, s4
s_cselect_b32 s49, 2621440, 0
s_cselect_b32 s52, 245760, 0
s_sub_u32 s44, s44, s49
s_sub_u32 s45, s45, s52
s_add_u32 s46, s46, 20480
s_cmp_eq_u32 s46, 143360
s_cselect_b32 s46, 0, s46
s_add_u32 m0, s46, s50
s_add_u32 s49, s44, 16384
buffer_load_dwordx4 v7, s[16:19], s44 offen lds
s_add_u32 s52, s50, 1024
s_add_u32 m0, s46, s52
s_nop 0
buffer_load_dwordx4 v7, s[16:19], s49 offen lds
s_add_u32 m0, s46, s51
s_add_u32 s44, s44, 131072
buffer_load_dwordx4 v8, s[20:23], s45 offen lds
buffer_load_dwordx4 v8, s[20:23], s45 offen offset:1024 lds
buffer_load_dwordx4 v8, s[20:23], s45 offen offset:2048 lds
s_add_u32 s45, s45, 12288
s_add_u32 s4, s4, 1
s_cmp_eq_u32 s4, 20
s_cselect_b32 s4, 0, s4
s_cselect_b32 s49, 2621440, 0
s_cselect_b32 s52, 245760, 0
s_sub_u32 s44, s44, s49
s_sub_u32 s45, s45, s52
s_add_u32 s46, s46, 20480
s_cmp_eq_u32 s46, 143360
s_cselect_b32 s46, 0, s46
s_add_u32 s24, s14, 0x10000
s_addc_u32 s25, s15, 0
s_mov_b32 s26, 0x3c000
s_mov_b32 s27, 0x20000
s_add_u32 s28, s14, 0xe00000
s_addc_u32 s29, s15, 0
s_mov_b32 s30, 0x600000
s_mov_b32 s31, 0x20000
s_add_u32 s32, s14, 0x160000
s_addc_u32 s33, s15, 0
s_mov_b32 s34, 0x5000
s_mov_b32 s35, 0x20000
s_add_u32 s36, s14, 0xc00000
s_addc_u32 s37, s15, 0
s_mov_b32 s38, 0x1e0000
s_mov_b32 s39, 0x20000
s_add_u32 s68, s14, 0x120000
s_addc_u32 s69, s15, 0
s_mov_b32 s70, 0x40000
s_mov_b32 s71, 0x20000
s_mov_b32 s76, s12
s_mov_b32 s77, s13
s_mov_b32 s78, 0x280000
s_mov_b32 s79, 0x20000
s_and_b32 s54, s41, 7
s_mul_i32 s54, s54, 48
s_mul_i32 s55, s58, 12
s_add_u32 s54, s54, s55
s_mul_i32 s54, s54, 5120
s_mul_i32 s55, s58, 5120
v_mov_b32 v16, 0
v_mov_b32 v17, 0
v_mov_b32 v18, 0
v_mov_b32 v19, 0
s_waitcnt vmcnt(10)
s_barrier
v_bfe_u32 v10, v9, 2, 2
v_lshrrev_b32 v11, 4, v9
v_bfe_u32 v2, v9, 1, 1
v_lshl_add_u32 v11, v11, 1, v2
v_lshlrev_b32 v2, 2, v10
v_xor_b32 v11, v11, v2
v_lshlrev_b32 v11, 4, v11
v_lshl_add_u32 v11, v10, 8, v11
v_and_b32 v2, 1, v9
v_lshl_add_u32 v11, v2, 3, v11
v_mov_b32 v20, 0x3f803f80
s_lshl_b32 s53, s58, 2
s_add_u32 s53, s53, 0
s_add_u32 s53, s53, s5
s_min_u32 s53, s53, 60
s_lshr_b32 s59, s53, 5
s_mul_i32 s59, s59, 20480
s_and_b32 s53, s53, 31
s_lshl_b32 s53, s53, 8
s_add_u32 s53, s53, s59
v_add_u32 v2, s53, v11
v_xor_b32 v10, 128, v2
ds_read_b64_tr_b16 v[40:41], v2
ds_read_b64_tr_b16 v[42:43], v10
s_lshl_b32 s53, s58, 2
s_add_u32 s53, s53, 16
s_add_u32 s53, s53, s5
s_min_u32 s53, s53, 60
s_lshr_b32 s59, s53, 5
s_mul_i32 s59, s59, 20480
s_and_b32 s53, s53, 31
s_lshl_b32 s53, s53, 8
s_add_u32 s53, s53, s59
v_add_u32 v2, s53, v11
v_xor_b32 v10, 128, v2
ds_read_b64_tr_b16 v[44:45], v2
ds_read_b64_tr_b16 v[46:47], v10
s_lshl_b32 s53, s58, 2
s_add_u32 s53, s53, 32
s_add_u32 s53, s53, s5
s_min_u32 s53, s53, 60
s_lshr_b32 s59, s53, 5
s_mul_i32 s59, s59, 20480
s_and_b32 s53, s53, 31
s_lshl_b32 s53, s53, 8
s_add_u32 s53, s53, s59
v_add_u32 v2, s53, v11
v_xor_b32 v10, 128, v2
ds_read_b64_tr_b16 v[48:49], v2
ds_read_b64_tr_b16 v[50:51], v10
s_add_u32 m0, s46, s50
s_add_u32 s49, s44, 16384
buffer_load_dwordx4 v7, s[16:19], s44 offen lds
s_add_u32 s52, s50, 1024
s_add_u32 m0, s46, s52
s_nop 0
buffer_load_dwordx4 v7, s[16:19], s49 offen lds
s_add_u32 m0, s46, s51
s_add_u32 s44, s44, 131072
buffer_load_dwordx4 v8, s[20:23], s45 offen lds
buffer_load_dwordx4 v8, s[20:23], s45 offen offset:1024 lds
buffer_load_dwordx4 v8, s[20:23], s45 offen offset:2048 lds
s_add_u32 s45, s45, 12288
s_add_u32 s4, s4, 1
s_cmp_eq_u32 s4, 20
s_cselect_b32 s4, 0, s4
s_cselect_b32 s49, 2621440, 0
s_cselect_b32 s52, 245760, 0
s_sub_u32 s44, s44, s49
s_sub_u32 s45, s45, s52
s_add_u32 s46, s46, 20480
s_cmp_eq_u32 s46, 143360
s_cselect_b32 s46, 0, s46
s_waitcnt lgkmcnt(0)
v_dot2_f32_bf16 v16, v40, v20, v16
v_dot2_f32_bf16 v17, v40, v40, v17
v_dot2_f32_bf16 v16, v41, v20, v16
v_dot2_f32_bf16 v17, v41, v41, v17
v_dot2_f32_bf16 v18, v42, v20, v18
v_dot2_f32_bf16 v19, v42, v42, v19
v_dot2_f32_bf16 v18, v43, v20, v18
v_dot2_f32_bf16 v19, v43, v43, v19
v_dot2_f32_bf16 v16, v44, v20, v16
v_dot2_f32_bf16 v17, v44, v44, v17
v_dot2_f32_bf16 v16, v45, v20, v16
v_dot2_f32_bf16 v17, v45, v45, v17
v_dot2_f32_bf16 v18, v46, v20, v18
v_dot2_f32_bf16 v19, v46, v46, v19
v_dot2_f32_bf16 v18, v47, v20, v18
v_dot2_f32_bf16 v19, v47, v47, v19
s_cmp_ge_u32 s58, 2
s_cbranch_scc1 k34_su_18
v_dot2_f32_bf16 v16, v48, v20, v16
v_dot2_f32_bf16 v17, v48, v48, v17
v_dot2_f32_bf16 v16, v49, v20, v16
v_dot2_f32_bf16 v17, v49, v49, v17
v_dot2_f32_bf16 v18, v50, v20, v18
v_dot2_f32_bf16 v19, v50, v50, v19
v_dot2_f32_bf16 v18, v51, v20, v18
v_dot2_f32_bf16 v19, v51, v51, v19
k34_su_18:
s_add_u32 m0, s46, s50
s_add_u32 s49, s44, 16384
buffer_load_dwordx4 v7, s[16:19], s44 offen lds
s_add_u32 s52, s50, 1024
s_add_u32 m0, s46, s52
s_nop 0
buffer_load_dwordx4 v7, s[16:19], s49 offen lds
s_add_u32 m0, s46, s51
s_add_u32 s44, s44, 131072
buffer_load_dwordx4 v8, s[20:23], s45 offen lds
buffer_load_dwordx4 v8, s[20:23], s45 offen offset:1024 lds
buffer_load_dwordx4 v8, s[20:23], s45 offen offset:2048 lds
s_add_u32 s45, s45, 12288
s_add_u32 s4, s4, 1
s_cmp_eq_u32 s4, 20
s_cselect_b32 s4, 0, s4
s_cselect_b32 s49, 2621440, 0
s_cselect_b32 s52, 245760, 0
s_sub_u32 s44, s44, s49
s_sub_u32 s45, s45, s52
s_add_u32 s46, s46, 20480
s_cmp_eq_u32 s46, 143360
s_cselect_b32 s46, 0, s46
s_waitcnt vmcnt(15)
s_barrier
s_add_u32 m0, s46, s50
s_add_u32 s49, s44, 16384
buffer_load_dwordx4 v7, s[16:19], s44 offen lds
s_lshl_b32 s53, s58, 10
s_add_u32 s53, s53, 143360
v_lshlrev_b32 v10, 3, v9
v_add_u32 v10, s53, v10
ds_write_b64 v10, v[16:17]
ds_write_b64 v10, v[18:19] offset:512
s_add_u32 s52, s50, 1024
s_add_u32 m0, s46, s52
s_nop 0
buffer_load_dwordx4 v7, s[16:19], s49 offen lds
s_add_u32 m0, s46, s51
s_add_u32 s44, s44, 131072
buffer_load_dwordx4 v8, s[20:23], s45 offen lds
buffer_load_dwordx4 v8, s[20:23], s45 offen offset:1024 lds
buffer_load_dwordx4 v8, s[20:23], s45 offen offset:2048 lds
s_add_u32 s45, s45, 12288
s_add_u32 s4, s4, 1
s_cmp_eq_u32 s4, 20
s_cselect_b32 s4, 0, s4
s_cselect_b32 s49, 2621440, 0
s_cselect_b32 s52, 245760, 0
s_sub_u32 s44, s44, s49
s_sub_u32 s45, s45, s52
s_add_u32 s46, s46, 20480
s_cmp_eq_u32 s46, 143360
s_cselect_b32 s46, 0, s46
s_waitcnt vmcnt(10)
s_waitcnt lgkmcnt(0)
s_barrier
s_cmp_ge_u32 s58, 2
s_cbranch_scc1 k34_nopub
v_subrev_u32 v9, 256, v0
v_lshlrev_b32 v10, 3, v9
v_add_u32 v11, 143360, v10
ds_read_b64 v[32:33], v11 offset:0
ds_read_b64 v[34:35], v11 offset:1024
ds_read_b64 v[36:37], v11 offset:2048
ds_read_b64 v[38:39], v11 offset:3072
k34_nopub:
s_add_u32 m0, s46, s50
s_add_u32 s49, s44, 16384
buffer_load_dwordx4 v7, s[16:19], s44 offen lds
s_add_u32 s52, s50, 1024
s_add_u32 m0, s46, s52
s_nop 0
buffer_load_dwordx4 v7, s[16:19], s49 offen lds
s_add_u32 m0, s46, s51
s_add_u32 s44, s44, 131072
buffer_load_dwordx4 v8, s[20:23], s45 offen lds
buffer_load_dwordx4 v8, s[20:23], s45 offen offset:1024 lds
buffer_load_dwordx4 v8, s[20:23], s45 offen offset:2048 lds
s_add_u32 s45, s45, 12288
s_add_u32 s4, s4, 1
s_cmp_eq_u32 s4, 20
s_cselect_b32 s4, 0, s4
s_cselect_b32 s49, 2621440, 0
s_cselect_b32 s52, 245760, 0
s_sub_u32 s44, s44, s49
s_sub_u32 s45, s45, s52
s_add_u32 s46, s46, 20480
s_cmp_eq_u32 s46, 143360
s_cselect_b32 s46, 0, s46
s_cmp_ge_u32 s58, 2
s_cbranch_scc1 k34_nopub2
s_waitcnt lgkmcnt(0)
v_add_f32 v32, v32, v34
v_add_f32 v36, v36, v38
v_add_f32 v32, v32, v36
v_add_f32 v33, v33, v35
v_add_f32 v37, v37, v39
v_add_f32 v33, v33, v37
s_lshl_b32 s53, s40, 4
s_add_u32 s53, s53, s41
s_lshl_b32 s53, s53, 10
buffer_store_dwordx2 v[32:33], v10, s[68:71], s53 offen sc1
k34_nopub2:
s_add_u32 m0, s46, s50
s_add_u32 s49, s44, 16384
buffer_load_dwordx4 v7, s[16:19], s44 offen lds
s_add_u32 s52, s50, 1024
s_add_u32 m0, s46, s52
s_nop 0
buffer_load_dwordx4 v7, s[16:19], s49 offen lds
s_add_u32 m0, s46, s51
s_add_u32 s44, s44, 131072
buffer_load_dwordx4 v8, s[20:23], s45 offen lds
buffer_load_dwordx4 v8, s[20:23], s45 offen offset:1024 lds
buffer_load_dwordx4 v8, s[20:23], s45 offen offset:2048 lds
s_add_u32 s45, s45, 12288
s_add_u32 s4, s4, 1
s_cmp_eq_u32 s4, 20
s_cselect_b32 s4, 0, s4
s_cselect_b32 s49, 2621440, 0
s_cselect_b32 s52, 245760, 0
s_sub_u32 s44, s44, s49
s_sub_u32 s45, s45, s52
s_add_u32 s46, s46, 20480
s_cmp_eq_u32 s46, 143360
s_cselect_b32 s46, 0, s46
s_waitcnt vmcnt(10)
s_barrier
s_cmp_eq_u32 s58, 3
s_cbranch_scc1 k34_nost_19
v_subrev_u32 v11, 256, v0
v_lshlrev_b32 v11, 3, v11
s_mul_i32 s53, s41, 1536
s_add_u32 s53, s53, 0
buffer_load_dwordx2 v[64:65], v11, s[24:27], s53 offen
s_add_u32 s53, s53, 24576
buffer_load_dwordx2 v[66:67], v11, s[24:27], s53 offen
s_add_u32 s53, s53, 24576
buffer_load_dwordx2 v[68:69], v11, s[24:27], s53 offen
s_add_u32 s53, s53, 24576
buffer_load_dwordx2 v[70:71], v11, s[24:27], s53 offen
s_add_u32 s53, s53, 24576
k34_nost_19:
s_add_u32 m0, s46, s50
s_add_u32 s49, s44, 16384
buffer_load_dwordx4 v7, s[16:19], s44 offen lds
s_add_u32 s52, s50, 1024
s_add_u32 m0, s46, s52
s_nop 0
buffer_load_dwordx4 v7, s[16:19], s49 offen lds
s_add_u32 m0, s46, s51
s_add_u32 s44, s44, 131072
buffer_load_dwordx4 v8, s[20:23], s45 offen lds
buffer_load_dwordx4 v8, s[20:23], s45 offen offset:1024 lds
buffer_load_dwordx4 v8, s[20:23], s45 offen offset:2048 lds
s_add_u32 s45, s45, 12288
s_add_u32 s4, s4, 1
s_cmp_eq_u32 s4, 20
s_cselect_b32 s4, 0, s4
s_cselect_b32 s49, 2621440, 0
s_cselect_b32 s52, 245760, 0
s_sub_u32 s44, s44, s49
s_sub_u32 s45, s45, s52
s_add_u32 s46, s46, 20480
s_cmp_eq_u32 s46, 143360
s_cselect_b32 s46, 0, s46
s_add_u32 m0, s46, s50
s_add_u32 s49, s44, 16384
buffer_load_dwordx4 v7, s[16:19], s44 offen lds
s_add_u32 s52, s50, 1024
s_add_u32 m0, s46, s52
s_nop 0
buffer_load_dwordx4 v7, s[16:19], s49 offen lds
s_add_u32 m0, s46, s51
s_add_u32 s44, s44, 131072
buffer_load_dwordx4 v8, s[20:23], s45 offen lds
buffer_load_dwordx4 v8, s[20:23], s45 offen offset:1024 lds
buffer_load_dwordx4 v8, s[20:23], s45 offen offset:2048 lds
s_add_u32 s45, s45, 12288
s_add_u32 s4, s4, 1
s_cmp_eq_u32 s4, 20
s_cselect_b32 s4, 0, s4
s_cselect_b32 s49, 2621440, 0
s_cselect_b32 s52, 245760, 0
s_sub_u32 s44, s44, s49
s_sub_u32 s45, s45, s52
s_add_u32 s46, s46, 20480
s_cmp_eq_u32 s46, 143360
s_cselect_b32 s46, 0, s46
s_waitcnt vmcnt(10)
s_barrier
s_cmp_lg_u32 s58, 0
s_cbranch_scc1 k34_c1_20
s_mov_b64 exec, 1
v_mov_b32 v11, 1
buffer_atomic_add v11, v5, s[32:35], 0 offen sc1
s_mov_b64 exec, -1
k34_c1_20:
s_cmp_eq_u32 s58, 3
s_cbranch_scc1 k34_nost_21
v_subrev_u32 v11, 256, v0
v_lshlrev_b32 v11, 3, v11
s_mul_i32 s53, s41, 1536
s_add_u32 s53, s53, 98304
buffer_load_dwordx2 v[72:73], v11, s[24:27], s53 offen
s_add_u32 s53, s53, 24576
buffer_load_dwordx2 v[74:75], v11, s[24:27], s53 offen
s_add_u32 s53, s53, 24576
buffer_load_dwordx2 v[76:77], v11, s[24:27], s53 offen
s_add_u32 s53, s53, 24576
k34_nost_21:
s_add_u32 m0, s46, s50
s_add_u32 s49, s44, 16384
buffer_load_dwordx4 v7, s[16:19], s44 offen lds
s_add_u32 s52, s50, 1024
s_add_u32 m0, s46, s52
s_nop 0
buffer_load_dwordx4 v7, s[16:19], s49 offen lds
s_add_u32 m0, s46, s51
s_add_u32 s44, s44, 131072
buffer_load_dwordx4 v8, s[20:23], s45 offen lds
buffer_load_dwordx4 v8, s[20:23], s45 offen offset:1024 lds
buffer_load_dwordx4 v8, s[20:23], s45 offen offset:2048 lds
s_add_u32 s45, s45, 12288
s_add_u32 s4, s4, 1
s_cmp_eq_u32 s4, 20
s_cselect_b32 s4, 0, s4
s_cselect_b32 s49, 2621440, 0
s_cselect_b32 s52, 245760, 0
s_sub_u32 s44, s44, s49
s_sub_u32 s45, s45, s52
s_add_u32 s46, s46, 20480
s_cmp_eq_u32 s46, 143360
s_cselect_b32 s46, 0, s46
s_add_u32 m0, s46, s50
s_add_u32 s49, s44, 16384
buffer_load_dwordx4 v7, s[16:19], s44 offen lds
s_add_u32 s52, s50, 1024
s_add_u32 m0, s46, s52
s_nop 0
buffer_load_dwordx4 v7, s[16:19], s49 offen lds
s_add_u32 m0, s46, s51
s_add_u32 s44, s44, 131072
buffer_load_dwordx4 v8, s[20:23], s45 offen lds
buffer_load_dwordx4 v8, s[20:23], s45 offen offset:1024 lds
buffer_load_dwordx4 v8, s[20:23], s45 offen offset:2048 lds
s_add_u32 s45, s45, 12288
s_add_u32 s4, s4, 1
s_cmp_eq_u32 s4, 20
s_cselect_b32 s4, 0, s4
s_cselect_b32 s49, 2621440, 0
s_cselect_b32 s52, 245760, 0
s_sub_u32 s44, s44, s49
s_sub_u32 s45, s45, s52
s_add_u32 s46, s46, 20480
s_cmp_eq_u32 s46, 143360
s_cselect_b32 s46, 0, s46
s_waitcnt vmcnt(10)
s_barrier
s_cmp_eq_u32 s58, 3
s_cbranch_scc1 k34_nost_22
v_subrev_u32 v11, 256, v0
v_lshlrev_b32 v11, 3, v11
s_mul_i32 s53, s41, 1536
s_add_u32 s53, s53, 172032
buffer_load_dwordx2 v[78:79], v11, s[24:27], s53 offen
s_add_u32 s53, s53, 24576
buffer_load_dwordx2 v[80:81], v11, s[24:27], s53 offen
s_add_u32 s53, s53, 24576
buffer_load_dwordx2 v[82:83], v11, s[24:27], s53 offen
s_add_u32 s53, s53, 24576
k34_nost_22:
s_add_u32 m0, s46, s50
s_add_u32 s49, s44, 16384
buffer_load_dwordx4 v7, s[16:19], s44 offen lds
s_add_u32 s52, s50, 1024
s_add_u32 m0, s46, s52
s_nop 0
buffer_load_dwordx4 v7, s[16:19], s49 offen lds
s_add_u32 m0, s46, s51
s_add_u32 s44, s44, 131072
buffer_load_dwordx4 v8, s[20:23], s45 offen lds
buffer_load_dwordx4 v8, s[20:23], s45 offen offset:1024 lds
buffer_load_dwordx4 v8, s[20:23], s45 offen offset:2048 lds
s_add_u32 s45, s45, 12288
s_add_u32 s4, s4, 1
s_cmp_eq_u32 s4, 20
s_cselect_b32 s4, 0, s4
s_cselect_b32 s49, 2621440, 0
s_cselect_b32 s52, 245760, 0
s_sub_u32 s44, s44, s49
s_sub_u32 s45, s45, s52
s_add_u32 s46, s46, 20480
s_cmp_eq_u32 s46, 143360
s_cselect_b32 s46, 0, s46
s_add_u32 m0, s46, s50
s_add_u32 s49, s44, 16384
buffer_load_dwordx4 v7, s[16:19], s44 offen lds
s_add_u32 s52, s50, 1024
s_add_u32 m0, s46, s52
s_nop 0
buffer_load_dwordx4 v7, s[16:19], s49 offen lds
s_add_u32 m0, s46, s51
s_add_u32 s44, s44, 131072
buffer_load_dwordx4 v8, s[20:23], s45 offen lds
buffer_load_dwordx4 v8, s[20:23], s45 offen offset:1024 lds
buffer_load_dwordx4 v8, s[20:23], s45 offen offset:2048 lds
s_add_u32 s45, s45, 12288
s_add_u32 s4, s4, 1
s_cmp_eq_u32 s4, 20
s_cselect_b32 s4, 0, s4
s_cselect_b32 s49, 2621440, 0
s_cselect_b32 s52, 245760, 0
s_sub_u32 s44, s44, s49
s_sub_u32 s45, s45, s52
s_add_u32 s46, s46, 20480
s_cmp_eq_u32 s46, 143360
s_cselect_b32 s46, 0, s46
s_waitcnt vmcnt(10)
s_barrier
s_cmp_lg_u32 s58, 0
s_cbranch_scc1 k34_np1
buffer_load_dword v6, v5, s[32:35], 0 offen sc1
k34_np1:
s_add_u32 m0, s46, s50
s_add_u32 s49, s44, 16384
buffer_load_dwordx4 v7, s[16:19], s44 offen lds
s_add_u32 s52, s50, 1024
s_add_u32 m0, s46, s52
s_nop 0
buffer_load_dwordx4 v7, s[16:19], s49 offen lds
s_add_u32 m0, s46, s51
s_add_u32 s44, s44, 131072
buffer_load_dwordx4 v8, s[20:23], s45 offen lds
buffer_load_dwordx4 v8, s[20:23], s45 offen offset:1024 lds
buffer_load_dwordx4 v8, s[20:23], s45 offen offset:2048 lds
s_add_u32 s45, s45, 12288
s_add_u32 s4, s4, 1
s_cmp_eq_u32 s4, 20
s_cselect_b32 s4, 0, s4
s_cselect_b32 s49, 2621440, 0
s_cselect_b32 s52, 245760, 0
s_sub_u32 s44, s44, s49
s_sub_u32 s45, s45, s52
s_add_u32 s46, s46, 20480
s_cmp_eq_u32 s46, 143360
s_cselect_b32 s46, 0, s46
s_add_u32 m0, s46, s50
s_add_u32 s49, s44, 16384
buffer_load_dwordx4 v7, s[16:19], s44 offen lds
s_add_u32 s52, s50, 1024
s_add_u32 m0, s46, s52
s_nop 0
buffer_load_dwordx4 v7, s[16:19], s49 offen lds
s_add_u32 m0, s46, s51
s_add_u32 s44, s44, 131072
buffer_load_dwordx4 v8, s[20:23], s45 offen lds
buffer_load_dwordx4 v8, s[20:23], s45 offen offset:1024 lds
buffer_load_dwordx4 v8, s[20:23], s45 offen offset:2048 lds
s_add_u32 s45, s45, 12288
s_add_u32 s4, s4, 1
s_cmp_eq_u32 s4, 20
s_cselect_b32 s4, 0, s4
s_cselect_b32 s49, 2621440, 0
s_cselect_b32 s52, 245760, 0
s_sub_u32 s44, s44, s49
s_sub_u32 s45, s45, s52
s_add_u32 s46, s46, 20480
s_cmp_eq_u32 s46, 143360
s_cselect_b32 s46, 0, s46
s_cmp_lg_u32 s58, 0
s_cbranch_scc1 k34_np2
s_waitcnt vmcnt(10)
s_mov_b32 s59, 4194304
k34_spin_23:
v_readfirstlane_b32 s60, v6
s_cmp_ge_u32 s60, 16
s_cbranch_scc1 k34_pdone_24
s_sub_u32 s59, s59, 1
s_cmp_eq_u32 s59, 0
s_cbranch_scc1 k34_pdone_24
s_sleep 1
buffer_load_dword v6, v5, s[32:35], 0 offen sc1
s_waitcnt vmcnt(0)
s_branch k34_spin_23
k34_pdone_24:
k34_np2:
s_waitcnt vmcnt(10)
s_barrier
s_lshl_b32 s53, s40, 4
s_add_u32 s53, s53, s58
s_lshl_b32 s53, s53, 10
buffer_load_dwordx4 v[32:35], v8, s[68:71], s53 offen sc1
s_add_u32 s53, s53, 4096
buffer_load_dwordx4 v[36:39], v8, s[68:71], s53 offen sc1
s_add_u32 s53, s53, 4096
buffer_load_dwordx4 v[40:43], v8, s[68:71], s53 offen sc1
s_add_u32 s53, s53, 4096
buffer_load_dwordx4 v[44:47], v8, s[68:71], s53 offen sc1
s_add_u32 s53, s53, 4096
s_add_u32 m0, s46, s50
s_add_u32 s49, s44, 16384
buffer_load_dwordx4 v7, s[16:19], s44 offen lds
s_add_u32 s52, s50, 1024
s_add_u32 m0, s46, s52
s_nop 0
buffer_load_dwordx4 v7, s[16:19], s49 offen lds
s_add_u32 m0, s46, s51
s_add_u32 s44, s44, 131072
buffer_load_dwordx4 v8, s[20:23], s45 offen lds
buffer_load_dwordx4 v8, s[20:23], s45 offen offset:1024 lds
buffer_load_dwordx4 v8, s[20:23], s45 offen offset:2048 lds
s_add_u32 s45, s45, 12288
s_add_u32 s4, s4, 1
s_cmp_eq_u32 s4, 20
s_cselect_b32 s4, 0, s4
s_cselect_b32 s49, 2621440, 0
s_cselect_b32 s52, 245760, 0
s_sub_u32 s44, s44, s49
s_sub_u32 s45, s45, s52
s_add_u32 s46, s46, 20480
s_cmp_eq_u32 s46, 143360
s_cselect_b32 s46, 0, s46
s_cmp_eq_u32 s58, 3
s_cbranch_scc1 k34_nost2
v_add_f32 v64, v64, v74
v_add_f32 v65, v65, v75
v_add_f32 v66, v66, v76
v_add_f32 v67, v67, v77
v_add_f32 v68, v68, v78
v_add_f32 v69, v69, v79
v_add_f32 v70, v70, v80
v_add_f32 v71, v71, v81
v_add_f32 v72, v72, v82
v_add_f32 v73, v73, v83
v_add_f32 v64, v64, v66
v_add_f32 v65, v65, v67
v_add_f32 v64, v64, v68
v_add_f32 v65, v65, v69
v_add_f32 v64, v64, v70
v_add_f32 v65, v65, v71
v_add_f32 v64, v64, v72
v_add_f32 v65, v65, v73
v_cvt_pk_bf16_f32 v66, v64, v64
v_cvt_pk_bf16_f32 v67, v65, v65
v_and_b32 v68, 0xffff0000, v66
v_and_b32 v69, 0xffff0000, v67
v_sub_f32 v68, v64, v68
v_sub_f32 v69, v65, v69
v_mov_b32 v72, v66
v_cvt_pk_bf16_f32 v73, v68, v65
v_cvt_pk_bf16_f32 v74, v65, v69
v_mov_b32 v75, 0
v_subrev_u32 v11, 256, v0
v_lshrrev_b32 v10, 5, v11
v_lshlrev_b32 v10, 4, v10
v_lshl_add_u32 v10, v11, 4, v10
v_add_u32 v10, 143360, v10
ds_write_b128 v10, v[72:75]
s_branch k34_nost3
k34_nost2:
v_and_b32 v11, 63, v0
v_cmp_gt_u32 vcc, 10, v11
s_and_saveexec_b64 s[60:61], vcc
v_mul_u32_u24 v10, 528, v11
v_add_u32 v10, 143872, v10
v_mov_b32 v76, 0
v_mov_b32 v77, 0
v_mov_b32 v78, 0
v_mov_b32 v79, 0
ds_write_b128 v10, v[76:79]
s_mov_b64 exec, s[60:61]
k34_nost3:
s_add_u32 m0, s46, s50
s_add_u32 s49, s44, 16384
buffer_load_dwordx4 v7, s[16:19], s44 offen lds
s_add_u32 s52, s50, 1024
s_add_u32 m0, s46, s52
s_nop 0
buffer_load_dwordx4 v7, s[16:19], s49 offen lds
s_add_u32 m0, s46, s51
s_add_u32 s44, s44, 131072
buffer_load_dwordx4 v8, s[20:23], s45 offen lds
buffer_load_dwordx4 v8, s[20:23], s45 offen offset:1024 lds
buffer_load_dwordx4 v8, s[20:23], s45 offen offset:2048 lds
s_add_u32 s45, s45, 12288
s_add_u32 s4, s4, 1
s_cmp_eq_u32 s4, 20
s_cselect_b32 s4, 0, s4
s_cselect_b32 s49, 2621440, 0
s_cselect_b32 s52, 245760, 0
s_sub_u32 s44, s44, s49
s_sub_u32 s45, s45, s52
s_add_u32 s46, s46, 20480
s_cmp_eq_u32 s46, 143360
s_cselect_b32 s46, 0, s46
s_waitcnt vmcnt(14)
s_barrier
s_add_u32 m0, s46, s50
s_add_u32 s49, s44, 16384
buffer_load_dwordx4 v7, s[16:19], s44 offen lds
s_add_u32 s52, s50, 1024
s_add_u32 m0, s46, s52
s_nop 0
buffer_load_dwordx4 v7, s[16:19], s49 offen lds
s_add_u32 m0, s46, s51
s_add_u32 s44, s44, 131072
buffer_load_dwordx4 v8, s[20:23], s45 offen lds
buffer_load_dwordx4 v8, s[20:23], s45 offen offset:1024 lds
buffer_load_dwordx4 v8, s[20:23], s45 offen offset:2048 lds
s_add_u32 s45, s45, 12288
s_add_u32 s4, s4, 1
s_cmp_eq_u32 s4, 20
s_cselect_b32 s4, 0, s4
s_cselect_b32 s49, 2621440, 0
s_cselect_b32 s52, 245760, 0
s_sub_u32 s44, s44, s49
s_sub_u32 s45, s45, s52
s_add_u32 s46, s46, 20480
s_cmp_eq_u32 s46, 143360
s_cselect_b32 s46, 0, s46
s_waitcnt vmcnt(15)
v_add_f32 v32, v32, v36
v_add_f32 v33, v33, v37
v_add_f32 v34, v34, v38
v_add_f32 v35, v35, v39
v_add_f32 v32, v32, v40
v_add_f32 v33, v33, v41
v_add_f32 v34, v34, v42
v_add_f32 v35, v35, v43
v_add_f32 v32, v32, v44
v_add_f32 v33, v33, v45
v_add_f32 v34, v34, v46
v_add_f32 v35, v35, v47
s_lshl_b32 s53, s58, 10
s_add_u32 s53, s53, 149664
v_add_u32 v10, s53, v8
ds_write_b128 v10, v[32:35]
s_add_u32 s6, s54, 30720
s_add_u32 m0, s55, 122880
s_nop 0
buffer_load_dwordx4 v8, s[36:39], s6 offen lds
buffer_load_dwordx4 v8, s[36:39], s6 offen offset:1024 lds
buffer_load_dwordx4 v8, s[36:39], s6 offen offset:2048 lds
buffer_load_dwordx4 v8, s[36:39], s6 offen offset:3072 lds
s_add_u32 s6, s6, 4096
s_add_u32 m0, s55, 126976
s_nop 0
buffer_load_dwordx4 v8, s[36:39], s6 offen lds
s_waitcnt vmcnt(10)
s_waitcnt lgkmcnt(0)
s_barrier
s_cmp_ge_u32 s58, 2
s_cbranch_scc1 k34_nofold0
v_subrev_u32 v9, 256, v0
v_lshlrev_b32 v10, 3, v9
v_add_u32 v10, 149664, v10
ds_read_b64 v[32:33], v10 offset:0
ds_read_b64 v[34:35], v10 offset:1024
ds_read_b64 v[36:37], v10 offset:2048
ds_read_b64 v[38:39], v10 offset:3072
k34_nofold0:
s_add_u32 s6, s54, 0
s_add_u32 m0, s55, 0
s_nop 0
buffer_load_dwordx4 v8, s[36:39], s6 offen lds
buffer_load_dwordx4 v8, s[36:39], s6 offen offset:1024 lds
buffer_load_dwordx4 v8, s[36:39], s6 offen offset:2048 lds
buffer_load_dwordx4 v8, s[36:39], s6 offen offset:3072 lds
s_add_u32 s6, s6, 4096
s_add_u32 m0, s55, 4096
s_nop 0
buffer_load_dwordx4 v8, s[36:39], s6 offen lds
s_cmp_ge_u32 s58, 2
s_cbranch_scc1 k34_nofold
s_waitcnt lgkmcnt(0)
v_add_f32 v32, v32, v34
v_add_f32 v36, v36, v38
v_add_f32 v32, v32, v36
v_add_f32 v33, v33, v35
v_add_f32 v37, v37, v39
v_add_f32 v33, v33, v37
v_mov_b32 v48, v33
v_mul_f32 v32, 0xbacccccd, v32
v_mul_f32 v48, 0x3acccccd, v48
v_fma_f32 v48, -v32, v32, v48
v_max_f32 v48, 0, v48
v_add_f32 v48, 0x3727c5ac, v48
v_sqrt_f32 v33, v48
v_rsq_f32 v34, v48
v_cvt_pk_bf16_f32 v35, v32, v32
v_cvt_pk_bf16_f32 v36, v33, v33
v_and_b32 v37, 0xffff0000, v35
v_and_b32 v38, 0xffff0000, v36
v_sub_f32 v37, v32, v37
v_sub_f32 v38, v33, v38
v_cvt_pk_bf16_f32 v40, v32, v37
v_cvt_pk_bf16_f32 v41, v32, v33
v_cvt_pk_bf16_f32 v42, v38, v33
v_mov_b32 v43, 0
v_lshrrev_b32 v10, 5, v9
v_lshlrev_b32 v10, 4, v10
v_lshl_add_u32 v10, v9, 4, v10
v_add_u32 v10, 146528, v10
ds_write_b128 v10, v[40:43]
v_mov_b32 v35, v48
v_lshlrev_b32 v10, 3, v9
v_add_u32 v10, 148640, v10
ds_write_b64 v10, v[34:35]
k34_nofold:
s_add_u32 s6, s54, 5120
s_add_u32 m0, s55, 20480
s_nop 0
buffer_load_dwordx4 v8, s[36:39], s6 offen lds
buffer_load_dwordx4 v8, s[36:39], s6 offen offset:1024 lds
buffer_load_dwordx4 v8, s[36:39], s6 offen offset:2048 lds
buffer_load_dwordx4 v8, s[36:39], s6 offen offset:3072 lds
s_add_u32 s6, s6, 4096
s_add_u32 m0, s55, 24576
s_nop 0
buffer_load_dwordx4 v8, s[36:39], s6 offen lds
s_waitcnt vmcnt(15)
s_waitcnt lgkmcnt(0)
s_barrier
s_add_u32 s6, s54, 10240
s_add_u32 m0, s55, 40960
s_nop 0
buffer_load_dwordx4 v8, s[36:39], s6 offen lds
buffer_load_dwordx4 v8, s[36:39], s6 offen offset:1024 lds
buffer_load_dwordx4 v8, s[36:39], s6 offen offset:2048 lds
buffer_load_dwordx4 v8, s[36:39], s6 offen offset:3072 lds
s_add_u32 s6, s6, 4096
s_add_u32 m0, s55, 45056
s_nop 0
buffer_load_dwordx4 v8, s[36:39], s6 offen lds
s_add_u32 s6, s54, 15360
s_add_u32 m0, s55, 61440
s_nop 0
buffer_load_dwordx4 v8, s[36:39], s6 offen lds
buffer_load_dwordx4 v8, s[36:39], s6 offen offset:1024 lds
buffer_load_dwordx4 v8, s[36:39], s6 offen offset:2048 lds
buffer_load_dwordx4 v8, s[36:39], s6 offen offset:3072 lds
s_add_u32 s6, s6, 4096
s_add_u32 m0, s55, 65536
s_nop 0
buffer_load_dwordx4 v8, s[36:39], s6 offen lds
s_add_u32 s53, s54, 35840
buffer_load_dwordx4 v[12:15], v8, s[36:39], s53 offen offset:0
buffer_load_dwordx4 v[16:19], v8, s[36:39], s53 offen offset:1024
buffer_load_dwordx4 v[20:23], v8, s[36:39], s53 offen offset:2048
buffer_load_dwordx4 v[24:27], v8, s[36:39], s53 offen offset:3072
s_add_u32 s53, s53, 4096
buffer_load_dwordx4 v[28:31], v8, s[36:39], s53 offen
s_add_u32 s53, s54, 40960
buffer_load_dwordx4 v[32:35], v8, s[36:39], s53 offen offset:0
buffer_load_dwordx4 v[36:39], v8, s[36:39], s53 offen offset:1024
buffer_load_dwordx4 v[40:43], v8, s[36:39], s53 offen offset:2048
buffer_load_dwordx4 v[44:47], v8, s[36:39], s53 offen offset:3072
s_add_u32 s53, s53, 4096
buffer_load_dwordx4 v[48:51], v8, s[36:39], s53 offen
s_add_u32 s53, s54, 46080
buffer_load_dwordx4 v[52:55], v8, s[36:39], s53 offen offset:0
buffer_load_dwordx4 v[56:59], v8, s[36:39], s53 offen offset:1024
buffer_load_dwordx4 v[60:63], v8, s[36:39], s53 offen offset:2048
buffer_load_dwordx4 v[64:67], v8, s[36:39], s53 offen offset:3072
s_add_u32 s53, s53, 4096
buffer_load_dwordx4 v[68:71], v8, s[36:39], s53 offen
s_lshr_b32 s61, s41, 3
s_lshl_b32 s62, s40, 1
s_add_u32 s61, s61, s62
s_mul_i32 s62, s61, 48
s_mul_i32 s63, s58, 12
s_add_u32 s62, s62, s63
s_lshl_b32 s62, s62, 12
s_add_u32 s63, s58, 0
s_and_b32 s63, s63, 3
s_lshl_b32 s63, s63, 10
s_add_u32 s72, s62, s63
s_add_u32 s63, s58, 1
s_and_b32 s63, s63, 3
s_lshl_b32 s63, s63, 10
s_add_u32 s73, s62, s63
s_add_u32 s63, s58, 2
s_and_b32 s63, s63, 3
s_lshl_b32 s63, s63, 10
s_add_u32 s74, s62, s63
s_add_u32 s63, s58, 3
s_and_b32 s63, s63, 3
s_lshl_b32 s63, s63, 10
s_add_u32 s75, s62, s63
v_add_u32 v4, s55, v8
s_lshl_b32 s53, s40, 1
s_lshr_b32 s6, s41, 3
s_add_u32 s53, s53, s6
s_lshl_b32 s53, s53, 2
s_add_u32 s53, s53, s58
s_lshl_b32 s53, s53, 7
s_add_u32 s53, s53, 2048
v_mov_b32 v5, s53
v_and_b32 v2, 63, v0
v_lshrrev_b32 v3, 4, v2
v_bfe_u32 v9, v2, 2, 2
v_lshl_add_u32 v9, v3, 2, v9
v_lshlrev_b32 v9, 7, v9
v_and_b32 v10, 3, v2
v_lshl_add_u32 v9, v10, 3, v9
s_lshl_b32 s50, s58, 5
s_add_u32 s50, s50, 149664
v_add_u32 v9, s50, v9
s_lshl_b32 s50, s61, 6
s_lshl_b32 s51, s58, 4
s_add_u32 s50, s50, s51
v_and_b32 v7, 15, v2
v_add_u32 v7, s50, v7
v_mul_u32_u24 v7, 1280, v7
v_lshl_add_u32 v7, v3, 3, v7
s_and_b32 s5, s41, 7
s_mul_i32 s50, s5, 160
v_add_u32 v7, s50, v7
s_mul_i32 s50, s58, 15360
s_add_u32 s50, s50, 0
v_add_u32 v10, s50, v8
v_lshlrev_b32 v11, 4, v3
v_add_u32 v11, 148640, v11
s_barrier
s_add_u32 s53, s54, 51200
buffer_load_dwordx4 v[72:75], v8, s[36:39], s53 offen offset:0
buffer_load_dwordx4 v[76:79], v8, s[36:39], s53 offen offset:1024
buffer_load_dwordx4 v[80:83], v8, s[36:39], s53 offen offset:2048
buffer_load_dwordx4 v[84:87], v8, s[36:39], s53 offen offset:3072
s_add_u32 s53, s53, 4096
buffer_load_dwordx4 v[88:91], v8, s[36:39], s53 offen
s_add_u32 s53, s54, 56320
buffer_load_dwordx4 v[92:95], v8, s[36:39], s53 offen offset:0
buffer_load_dwordx4 v[96:99], v8, s[36:39], s53 offen offset:1024
buffer_load_dwordx4 v[100:103], v8, s[36:39], s53 offen offset:2048
buffer_load_dwordx4 v[104:107], v8, s[36:39], s53 offen offset:3072
s_add_u32 s53, s53, 4096
buffer_load_dwordx4 v[108:111], v8, s[36:39], s53 offen
s_add_u32 s6, s54, 20480
s_add_u32 m0, s55, 81920
s_nop 0
buffer_load_dwordx4 v8, s[36:39], s6 offen lds
buffer_load_dwordx4 v8, s[36:39], s6 offen offset:1024 lds
buffer_load_dwordx4 v8, s[36:39], s6 offen offset:2048 lds
buffer_load_dwordx4 v8, s[36:39], s6 offen offset:3072 lds
s_add_u32 s6, s6, 4096
s_add_u32 m0, s55, 86016
s_nop 0
buffer_load_dwordx4 v8, s[36:39], s6 offen lds
buffer_load_dword v6, v5, s[32:35], 0 offen sc1
s_add_u32 s6, s54, 25600
s_add_u32 m0, s55, 102400
s_nop 0
buffer_load_dwordx4 v8, s[36:39], s6 offen lds
buffer_load_dwordx4 v8, s[36:39], s6 offen offset:1024 lds
buffer_load_dwordx4 v8, s[36:39], s6 offen offset:2048 lds
buffer_load_dwordx4 v8, s[36:39], s6 offen offset:3072 lds
s_add_u32 s6, s6, 4096
s_add_u32 m0, s55, 106496
s_nop 0
buffer_load_dwordx4 v8, s[36:39], s6 offen lds
s_waitcnt vmcnt(5)
s_mov_b32 s59, 4194304
k34_spin_25:
v_readfirstlane_b32 s60, v6
s_cmp_ge_u32 s60, 8
s_cbranch_scc1 k34_pdone_26
s_sub_u32 s59, s59, 1
s_cmp_eq_u32 s59, 0
s_cbranch_scc1 k34_pdone_26
s_sleep 2
buffer_load_dword v6, v5, s[32:35], 0 offen sc1
s_waitcnt vmcnt(0)
s_branch k34_spin_25
k34_pdone_26:
s_add_u32 s63, s72, 28672
buffer_load_dwordx4 v[112:115], v8, s[28:31], s63 offen sc1
s_add_u32 s63, s73, 28672
buffer_load_dwordx4 v[116:119], v8, s[28:31], s63 offen sc1
s_add_u32 s63, s74, 28672
buffer_load_dwordx4 v[120:123], v8, s[28:31], s63 offen sc1
s_add_u32 s63, s75, 28672
buffer_load_dwordx4 v[124:127], v8, s[28:31], s63 offen sc1
s_add_u32 s63, s72, 32768
buffer_load_dwordx4 v[128:131], v8, s[28:31], s63 offen sc1
s_add_u32 s63, s73, 32768
buffer_load_dwordx4 v[132:135], v8, s[28:31], s63 offen sc1
s_add_u32 s63, s74, 32768
buffer_load_dwordx4 v[136:139], v8, s[28:31], s63 offen sc1
s_add_u32 s63, s75, 32768
buffer_load_dwordx4 v[140:143], v8, s[28:31], s63 offen sc1
s_add_u32 s63, s72, 36864
buffer_load_dwordx4 v[144:147], v8, s[28:31], s63 offen sc1
s_add_u32 s63, s73, 36864
buffer_load_dwordx4 v[148:151], v8, s[28:31], s63 offen sc1
s_add_u32 s63, s74, 36864
buffer_load_dwordx4 v[152:155], v8, s[28:31], s63 offen sc1
s_add_u32 s63, s75, 36864
buffer_load_dwordx4 v[156:159], v8, s[28:31], s63 offen sc1
s_add_u32 s63, s72, 40960
buffer_load_dwordx4 v[160:163], v8, s[28:31], s63 offen sc1
s_add_u32 s63, s73, 40960
buffer_load_dwordx4 v[164:167], v8, s[28:31], s63 offen sc1
s_add_u32 s63, s74, 40960
buffer_load_dwordx4 v[168:171], v8, s[28:31], s63 offen sc1
s_add_u32 s63, s75, 40960
buffer_load_dwordx4 v[172:175], v8, s[28:31], s63 offen sc1
s_waitcnt vmcnt(12)
v_mfma_f32_16x16x32_bf16 a[0:3], v[12:15], v[112:115], 0
v_mfma_f32_16x16x32_bf16 a[20:23], v[12:15], v[116:119], 0
v_mfma_f32_16x16x32_bf16 a[40:43], v[12:15], v[120:123], 0
v_mfma_f32_16x16x32_bf16 a[60:63], v[12:15], v[124:127], 0
v_mfma_f32_16x16x32_bf16 a[4:7], v[16:19], v[112:115], 0
v_mfma_f32_16x16x32_bf16 a[24:27], v[16:19], v[116:119], 0
v_mfma_f32_16x16x32_bf16 a[44:47], v[16:19], v[120:123], 0
v_mfma_f32_16x16x32_bf16 a[64:67], v[16:19], v[124:127], 0
v_mfma_f32_16x16x32_bf16 a[8:11], v[20:23], v[112:115], 0
v_mfma_f32_16x16x32_bf16 a[28:31], v[20:23], v[116:119], 0
v_mfma_f32_16x16x32_bf16 a[48:51], v[20:23], v[120:123], 0
v_mfma_f32_16x16x32_bf16 a[68:71], v[20:23], v[124:127], 0
v_mfma_f32_16x16x32_bf16 a[12:15], v[24:27], v[112:115], 0
v_mfma_f32_16x16x32_bf16 a[32:35], v[24:27], v[116:119], 0
v_mfma_f32_16x16x32_bf16 a[52:55], v[24:27], v[120:123], 0
v_mfma_f32_16x16x32_bf16 a[72:75], v[24:27], v[124:127], 0
v_mfma_f32_16x16x32_bf16 a[16:19], v[28:31], v[112:115], 0
v_mfma_f32_16x16x32_bf16 a[36:39], v[28:31], v[116:119], 0
v_mfma_f32_16x16x32_bf16 a[56:59], v[28:31], v[120:123], 0
v_mfma_f32_16x16x32_bf16 a[76:79], v[28:31], v[124:127], 0
s_waitcnt vmcnt(8)
v_mfma_f32_16x16x32_bf16 a[0:3], v[32:35], v[128:131], a[0:3]
ds_read_b128 v[12:15], v4 offset:0
v_mfma_f32_16x16x32_bf16 a[20:23], v[32:35], v[132:135], a[20:23]
ds_read_b128 v[16:19], v4 offset:1024
v_mfma_f32_16x16x32_bf16 a[40:43], v[32:35], v[136:139], a[40:43]
ds_read_b128 v[20:23], v4 offset:2048
v_mfma_f32_16x16x32_bf16 a[60:63], v[32:35], v[140:143], a[60:63]
ds_read_b128 v[24:27], v4 offset:3072
v_mfma_f32_16x16x32_bf16 a[4:7], v[36:39], v[128:131], a[4:7]
ds_read_b128 v[28:31], v4 offset:4096
v_mfma_f32_16x16x32_bf16 a[24:27], v[36:39], v[132:135], a[24:27]
s_add_u32 s63, s72, 45056
v_mfma_f32_16x16x32_bf16 a[44:47], v[36:39], v[136:139], a[44:47]
buffer_load_dwordx4 v[112:115], v8, s[28:31], s63 offen sc1
v_mfma_f32_16x16x32_bf16 a[64:67], v[36:39], v[140:143], a[64:67]
s_add_u32 s63, s73, 45056
v_mfma_f32_16x16x32_bf16 a[8:11], v[40:43], v[128:131], a[8:11]
buffer_load_dwordx4 v[116:119], v8, s[28:31], s63 offen sc1
v_mfma_f32_16x16x32_bf16 a[28:31], v[40:43], v[132:135], a[28:31]
s_add_u32 s63, s74, 45056
v_mfma_f32_16x16x32_bf16 a[48:51], v[40:43], v[136:139], a[48:51]
buffer_load_dwordx4 v[120:123], v8, s[28:31], s63 offen sc1
v_mfma_f32_16x16x32_bf16 a[68:71], v[40:43], v[140:143], a[68:71]
s_add_u32 s63, s75, 45056
v_mfma_f32_16x16x32_bf16 a[12:15], v[44:47], v[128:131], a[12:15]
buffer_load_dwordx4 v[124:127], v8, s[28:31], s63 offen sc1
v_mfma_f32_16x16x32_bf16 a[32:35], v[44:47], v[132:135], a[32:35]
v_mfma_f32_16x16x32_bf16 a[52:55], v[44:47], v[136:139], a[52:55]
v_mfma_f32_16x16x32_bf16 a[72:75], v[44:47], v[140:143], a[72:75]
v_mfma_f32_16x16x32_bf16 a[16:19], v[48:51], v[128:131], a[16:19]
v_mfma_f32_16x16x32_bf16 a[36:39], v[48:51], v[132:135], a[36:39]
v_mfma_f32_16x16x32_bf16 a[56:59], v[48:51], v[136:139], a[56:59]
v_mfma_f32_16x16x32_bf16 a[76:79], v[48:51], v[140:143], a[76:79]
s_waitcnt vmcnt(8)
v_mfma_f32_16x16x32_bf16 a[0:3], v[52:55], v[144:147], a[0:3]
ds_read_b128 v[32:35], v4 offset:20480
v_mfma_f32_16x16x32_bf16 a[20:23], v[52:55], v[148:151], a[20:23]
ds_read_b128 v[36:39], v4 offset:21504
v_mfma_f32_16x16x32_bf16 a[40:43], v[52:55], v[152:155], a[40:43]
ds_read_b128 v[40:43], v4 offset:22528
v_mfma_f32_16x16x32_bf16 a[60:63], v[52:55], v[156:159], a[60:63]
ds_read_b128 v[44:47], v4 offset:23552
v_mfma_f32_16x16x32_bf16 a[4:7], v[56:59], v[144:147], a[4:7]
ds_read_b128 v[48:51], v4 offset:24576
v_mfma_f32_16x16x32_bf16 a[24:27], v[56:59], v[148:151], a[24:27]
s_add_u32 s63, s72, 0
v_mfma_f32_16x16x32_bf16 a[44:47], v[56:59], v[152:155], a[44:47]
buffer_load_dwordx4 v[128:131], v8, s[28:31], s63 offen sc1
v_mfma_f32_16x16x32_bf16 a[64:67], v[56:59], v[156:159], a[64:67]
s_add_u32 s63, s73, 0
v_mfma_f32_16x16x32_bf16 a[8:11], v[60:63], v[144:147], a[8:11]
buffer_load_dwordx4 v[132:135], v8, s[28:31], s63 offen sc1
v_mfma_f32_16x16x32_bf16 a[28:31], v[60:63], v[148:151], a[28:31]
s_add_u32 s63, s74, 0
v_mfma_f32_16x16x32_bf16 a[48:51], v[60:63], v[152:155], a[48:51]
buffer_load_dwordx4 v[136:139], v8, s[28:31], s63 offen sc1
v_mfma_f32_16x16x32_bf16 a[68:71], v[60:63], v[156:159], a[68:71]
s_add_u32 s63, s75, 0
v_mfma_f32_16x16x32_bf16 a[12:15], v[64:67], v[144:147], a[12:15]
buffer_load_dwordx4 v[140:143], v8, s[28:31], s63 offen sc1
v_mfma_f32_16x16x32_bf16 a[32:35], v[64:67], v[148:151], a[32:35]
v_mfma_f32_16x16x32_bf16 a[52:55], v[64:67], v[152:155], a[52:55]
v_mfma_f32_16x16x32_bf16 a[72:75], v[64:67], v[156:159], a[72:75]
v_mfma_f32_16x16x32_bf16 a[16:19], v[68:71], v[144:147], a[16:19]
v_mfma_f32_16x16x32_bf16 a[36:39], v[68:71], v[148:151], a[36:39]
v_mfma_f32_16x16x32_bf16 a[56:59], v[68:71], v[152:155], a[56:59]
v_mfma_f32_16x16x32_bf16 a[76:79], v[68:71], v[156:159], a[76:79]
s_waitcnt vmcnt(8)
v_mfma_f32_16x16x32_bf16 a[0:3], v[72:75], v[160:163], a[0:3]
ds_read_b128 v[52:55], v4 offset:40960
v_mfma_f32_16x16x32_bf16 a[20:23], v[72:75], v[164:167], a[20:23]
ds_read_b128 v[56:59], v4 offset:41984
v_mfma_f32_16x16x32_bf16 a[40:43], v[72:75], v[168:171], a[40:43]
ds_read_b128 v[60:63], v4 offset:43008
v_mfma_f32_16x16x32_bf16 a[60:63], v[72:75], v[172:175], a[60:63]
ds_read_b128 v[64:67], v4 offset:44032
v_mfma_f32_16x16x32_bf16 a[4:7], v[76:79], v[160:163], a[4:7]
ds_read_b128 v[68:71], v4 offset:45056
v_mfma_f32_16x16x32_bf16 a[24:27], v[76:79], v[164:167], a[24:27]
s_add_u32 s63, s72, 4096
v_mfma_f32_16x16x32_bf16 a[44:47], v[76:79], v[168:171], a[44:47]
buffer_load_dwordx4 v[144:147], v8, s[28:31], s63 offen sc1
v_mfma_f32_16x16x32_bf16 a[64:67], v[76:79], v[172:175], a[64:67]
s_add_u32 s63, s73, 4096
v_mfma_f32_16x16x32_bf16 a[8:11], v[80:83], v[160:163], a[8:11]
buffer_load_dwordx4 v[148:151], v8, s[28:31], s63 offen sc1
v_mfma_f32_16x16x32_bf16 a[28:31], v[80:83], v[164:167], a[28:31]
s_add_u32 s63, s74, 4096
v_mfma_f32_16x16x32_bf16 a[48:51], v[80:83], v[168:171], a[48:51]
buffer_load_dwordx4 v[152:155], v8, s[28:31], s63 offen sc1
v_mfma_f32_16x16x32_bf16 a[68:71], v[80:83], v[172:175], a[68:71]
s_add_u32 s63, s75, 4096
v_mfma_f32_16x16x32_bf16 a[12:15], v[84:87], v[160:163], a[12:15]
buffer_load_dwordx4 v[156:159], v8, s[28:31], s63 offen sc1
v_mfma_f32_16x16x32_bf16 a[32:35], v[84:87], v[164:167], a[32:35]
v_mfma_f32_16x16x32_bf16 a[52:55], v[84:87], v[168:171], a[52:55]
v_mfma_f32_16x16x32_bf16 a[72:75], v[84:87], v[172:175], a[72:75]
v_mfma_f32_16x16x32_bf16 a[16:19], v[88:91], v[160:163], a[16:19]
v_mfma_f32_16x16x32_bf16 a[36:39], v[88:91], v[164:167], a[36:39]
v_mfma_f32_16x16x32_bf16 a[56:59], v[88:91], v[168:171], a[56:59]
v_mfma_f32_16x16x32_bf16 a[76:79], v[88:91], v[172:175], a[76:79]
s_waitcnt vmcnt(8)
v_mfma_f32_16x16x32_bf16 a[0:3], v[92:95], v[112:115], a[0:3]
v_add_u32 v3, 61440, v4
v_mfma_f32_16x16x32_bf16 a[20:23], v[92:95], v[116:119], a[20:23]
ds_read_b128 v[72:75], v3 offset:0
v_mfma_f32_16x16x32_bf16 a[40:43], v[92:95], v[120:123], a[40:43]
ds_read_b128 v[76:79], v3 offset:1024
v_mfma_f32_16x16x32_bf16 a[60:63], v[92:95], v[124:127], a[60:63]
ds_read_b128 v[80:83], v3 offset:2048
v_mfma_f32_16x16x32_bf16 a[4:7], v[96:99], v[112:115], a[4:7]
ds_read_b128 v[84:87], v3 offset:3072
v_mfma_f32_16x16x32_bf16 a[24:27], v[96:99], v[116:119], a[24:27]
ds_read_b128 v[88:91], v3 offset:4096
v_mfma_f32_16x16x32_bf16 a[44:47], v[96:99], v[120:123], a[44:47]
s_add_u32 s63, s72, 8192
v_mfma_f32_16x16x32_bf16 a[64:67], v[96:99], v[124:127], a[64:67]
buffer_load_dwordx4 v[160:163], v8, s[28:31], s63 offen sc1
v_mfma_f32_16x16x32_bf16 a[8:11], v[100:103], v[112:115], a[8:11]
s_add_u32 s63, s73, 8192
v_mfma_f32_16x16x32_bf16 a[28:31], v[100:103], v[116:119], a[28:31]
buffer_load_dwordx4 v[164:167], v8, s[28:31], s63 offen sc1
v_mfma_f32_16x16x32_bf16 a[48:51], v[100:103], v[120:123], a[48:51]
s_add_u32 s63, s74, 8192
v_mfma_f32_16x16x32_bf16 a[68:71], v[100:103], v[124:127], a[68:71]
buffer_load_dwordx4 v[168:171], v8, s[28:31], s63 offen sc1
v_mfma_f32_16x16x32_bf16 a[12:15], v[104:107], v[112:115], a[12:15]
s_add_u32 s63, s75, 8192
v_mfma_f32_16x16x32_bf16 a[32:35], v[104:107], v[116:119], a[32:35]
buffer_load_dwordx4 v[172:175], v8, s[28:31], s63 offen sc1
v_mfma_f32_16x16x32_bf16 a[52:55], v[104:107], v[120:123], a[52:55]
v_mfma_f32_16x16x32_bf16 a[72:75], v[104:107], v[124:127], a[72:75]
v_mfma_f32_16x16x32_bf16 a[16:19], v[108:111], v[112:115], a[16:19]
v_mfma_f32_16x16x32_bf16 a[36:39], v[108:111], v[116:119], a[36:39]
v_mfma_f32_16x16x32_bf16 a[56:59], v[108:111], v[120:123], a[56:59]
v_mfma_f32_16x16x32_bf16 a[76:79], v[108:111], v[124:127], a[76:79]
s_waitcnt vmcnt(8)
s_waitcnt lgkmcnt(0)
v_mfma_f32_16x16x32_bf16 a[0:3], v[12:15], v[128:131], a[0:3]
v_add_u32 v3, 81920, v4
v_mfma_f32_16x16x32_bf16 a[20:23], v[12:15], v[132:135], a[20:23]
ds_read_b128 v[92:95], v3 offset:0
v_mfma_f32_16x16x32_bf16 a[40:43], v[12:15], v[136:139], a[40:43]
ds_read_b128 v[96:99], v3 offset:1024
v_mfma_f32_16x16x32_bf16 a[60:63], v[12:15], v[140:143], a[60:63]
ds_read_b128 v[100:103], v3 offset:2048
v_mfma_f32_16x16x32_bf16 a[4:7], v[16:19], v[128:131], a[4:7]
ds_read_b128 v[104:107], v3 offset:3072
v_mfma_f32_16x16x32_bf16 a[24:27], v[16:19], v[132:135], a[24:27]
ds_read_b128 v[108:111], v3 offset:4096
v_mfma_f32_16x16x32_bf16 a[44:47], v[16:19], v[136:139], a[44:47]
s_add_u32 s63, s72, 12288
v_mfma_f32_16x16x32_bf16 a[64:67], v[16:19], v[140:143], a[64:67]
buffer_load_dwordx4 v[112:115], v8, s[28:31], s63 offen sc1
v_mfma_f32_16x16x32_bf16 a[8:11], v[20:23], v[128:131], a[8:11]
s_add_u32 s63, s73, 12288
v_mfma_f32_16x16x32_bf16 a[28:31], v[20:23], v[132:135], a[28:31]
buffer_load_dwordx4 v[116:119], v8, s[28:31], s63 offen sc1
v_mfma_f32_16x16x32_bf16 a[48:51], v[20:23], v[136:139], a[48:51]
s_add_u32 s63, s74, 12288
v_mfma_f32_16x16x32_bf16 a[68:71], v[20:23], v[140:143], a[68:71]
buffer_load_dwordx4 v[120:123], v8, s[28:31], s63 offen sc1
v_mfma_f32_16x16x32_bf16 a[12:15], v[24:27], v[128:131], a[12:15]
s_add_u32 s63, s75, 12288
v_mfma_f32_16x16x32_bf16 a[32:35], v[24:27], v[132:135], a[32:35]
buffer_load_dwordx4 v[124:127], v8, s[28:31], s63 offen sc1
v_mfma_f32_16x16x32_bf16 a[52:55], v[24:27], v[136:139], a[52:55]
v_mfma_f32_16x16x32_bf16 a[72:75], v[24:27], v[140:143], a[72:75]
v_mfma_f32_16x16x32_bf16 a[16:19], v[28:31], v[128:131], a[16:19]
v_mfma_f32_16x16x32_bf16 a[36:39], v[28:31], v[132:135], a[36:39]
v_mfma_f32_16x16x32_bf16 a[56:59], v[28:31], v[136:139], a[56:59]
v_mfma_f32_16x16x32_bf16 a[76:79], v[28:31], v[140:143], a[76:79]
s_waitcnt vmcnt(8)
s_waitcnt lgkmcnt(0)
v_mfma_f32_16x16x32_bf16 a[0:3], v[32:35], v[144:147], a[0:3]
v_add_u32 v3, 102400, v4
v_mfma_f32_16x16x32_bf16 a[20:23], v[32:35], v[148:151], a[20:23]
ds_read_b128 v[12:15], v3 offset:0
v_mfma_f32_16x16x32_bf16 a[40:43], v[32:35], v[152:155], a[40:43]
ds_read_b128 v[16:19], v3 offset:1024
v_mfma_f32_16x16x32_bf16 a[60:63], v[32:35], v[156:159], a[60:63]
ds_read_b128 v[20:23], v3 offset:2048
v_mfma_f32_16x16x32_bf16 a[4:7], v[36:39], v[144:147], a[4:7]
ds_read_b128 v[24:27], v3 offset:3072
v_mfma_f32_16x16x32_bf16 a[24:27], v[36:39], v[148:151], a[24:27]
ds_read_b128 v[28:31], v3 offset:4096
v_mfma_f32_16x16x32_bf16 a[44:47], v[36:39], v[152:155], a[44:47]
s_add_u32 s63, s72, 16384
v_mfma_f32_16x16x32_bf16 a[64:67], v[36:39], v[156:159], a[64:67]
buffer_load_dwordx4 v[128:131], v8, s[28:31], s63 offen sc1
v_mfma_f32_16x16x32_bf16 a[8:11], v[40:43], v[144:147], a[8:11]
s_add_u32 s63, s73, 16384
v_mfma_f32_16x16x32_bf16 a[28:31], v[40:43], v[148:151], a[28:31]
buffer_load_dwordx4 v[132:135], v8, s[28:31], s63 offen sc1
v_mfma_f32_16x16x32_bf16 a[48:51], v[40:43], v[152:155], a[48:51]
s_add_u32 s63, s74, 16384
v_mfma_f32_16x16x32_bf16 a[68:71], v[40:43], v[156:159], a[68:71]
buffer_load_dwordx4 v[136:139], v8, s[28:31], s63 offen sc1
v_mfma_f32_16x16x32_bf16 a[12:15], v[44:47], v[144:147], a[12:15]
s_add_u32 s63, s75, 16384
v_mfma_f32_16x16x32_bf16 a[32:35], v[44:47], v[148:151], a[32:35]
buffer_load_dwordx4 v[140:143], v8, s[28:31], s63 offen sc1
v_mfma_f32_16x16x32_bf16 a[52:55], v[44:47], v[152:155], a[52:55]
v_mfma_f32_16x16x32_bf16 a[72:75], v[44:47], v[156:159], a[72:75]
v_mfma_f32_16x16x32_bf16 a[16:19], v[48:51], v[144:147], a[16:19]
v_mfma_f32_16x16x32_bf16 a[36:39], v[48:51], v[148:151], a[36:39]
v_mfma_f32_16x16x32_bf16 a[56:59], v[48:51], v[152:155], a[56:59]
v_mfma_f32_16x16x32_bf16 a[76:79], v[48:51], v[156:159], a[76:79]
s_waitcnt vmcnt(8)
s_waitcnt lgkmcnt(0)
v_mfma_f32_16x16x32_bf16 a[0:3], v[52:55], v[160:163], a[0:3]
v_add_u32 v3, 122880, v4
v_mfma_f32_16x16x32_bf16 a[20:23], v[52:55], v[164:167], a[20:23]
ds_read_b128 v[32:35], v3 offset:0
v_mfma_f32_16x16x32_bf16 a[40:43], v[52:55], v[168:171], a[40:43]
ds_read_b128 v[36:39], v3 offset:1024
v_mfma_f32_16x16x32_bf16 a[60:63], v[52:55], v[172:175], a[60:63]
ds_read_b128 v[40:43], v3 offset:2048
v_mfma_f32_16x16x32_bf16 a[4:7], v[56:59], v[160:163], a[4:7]
ds_read_b128 v[44:47], v3 offset:3072
v_mfma_f32_16x16x32_bf16 a[24:27], v[56:59], v[164:167], a[24:27]
ds_read_b128 v[48:51], v3 offset:4096
v_mfma_f32_16x16x32_bf16 a[44:47], v[56:59], v[168:171], a[44:47]
s_add_u32 s63, s72, 20480
v_mfma_f32_16x16x32_bf16 a[64:67], v[56:59], v[172:175], a[64:67]
buffer_load_dwordx4 v[144:147], v8, s[28:31], s63 offen sc1
v_mfma_f32_16x16x32_bf16 a[8:11], v[60:63], v[160:163], a[8:11]
s_add_u32 s63, s73, 20480
v_mfma_f32_16x16x32_bf16 a[28:31], v[60:63], v[164:167], a[28:31]
buffer_load_dwordx4 v[148:151], v8, s[28:31], s63 offen sc1
v_mfma_f32_16x16x32_bf16 a[48:51], v[60:63], v[168:171], a[48:51]
s_add_u32 s63, s74, 20480
v_mfma_f32_16x16x32_bf16 a[68:71], v[60:63], v[172:175], a[68:71]
buffer_load_dwordx4 v[152:155], v8, s[28:31], s63 offen sc1
v_mfma_f32_16x16x32_bf16 a[12:15], v[64:67], v[160:163], a[12:15]
s_add_u32 s63, s75, 20480
v_mfma_f32_16x16x32_bf16 a[32:35], v[64:67], v[164:167], a[32:35]
buffer_load_dwordx4 v[156:159], v8, s[28:31], s63 offen sc1
v_mfma_f32_16x16x32_bf16 a[52:55], v[64:67], v[168:171], a[52:55]
v_mfma_f32_16x16x32_bf16 a[72:75], v[64:67], v[172:175], a[72:75]
v_mfma_f32_16x16x32_bf16 a[16:19], v[68:71], v[160:163], a[16:19]
v_mfma_f32_16x16x32_bf16 a[36:39], v[68:71], v[164:167], a[36:39]
v_mfma_f32_16x16x32_bf16 a[56:59], v[68:71], v[168:171], a[56:59]
v_mfma_f32_16x16x32_bf16 a[76:79], v[68:71], v[172:175], a[76:79]
s_waitcnt vmcnt(8)
s_waitcnt lgkmcnt(0)
v_mfma_f32_16x16x32_bf16 a[0:3], v[72:75], v[112:115], a[0:3]
s_add_u32 s63, s72, 24576
v_mfma_f32_16x16x32_bf16 a[20:23], v[72:75], v[116:119], a[20:23]
buffer_load_dwordx4 v[160:163], v8, s[28:31], s63 offen sc1
v_mfma_f32_16x16x32_bf16 a[40:43], v[72:75], v[120:123], a[40:43]
s_add_u32 s63, s73, 24576
v_mfma_f32_16x16x32_bf16 a[60:63], v[72:75], v[124:127], a[60:63]
buffer_load_dwordx4 v[164:167], v8, s[28:31], s63 offen sc1
v_mfma_f32_16x16x32_bf16 a[4:7], v[76:79], v[112:115], a[4:7]
s_add_u32 s63, s74, 24576
v_mfma_f32_16x16x32_bf16 a[24:27], v[76:79], v[116:119], a[24:27]
buffer_load_dwordx4 v[168:171], v8, s[28:31], s63 offen sc1
v_mfma_f32_16x16x32_bf16 a[44:47], v[76:79], v[120:123], a[44:47]
s_add_u32 s63, s75, 24576
v_mfma_f32_16x16x32_bf16 a[64:67], v[76:79], v[124:127], a[64:67]
buffer_load_dwordx4 v[172:175], v8, s[28:31], s63 offen sc1
v_mfma_f32_16x16x32_bf16 a[8:11], v[80:83], v[112:115], a[8:11]
v_mfma_f32_16x16x32_bf16 a[28:31], v[80:83], v[116:119], a[28:31]
v_mfma_f32_16x16x32_bf16 a[48:51], v[80:83], v[120:123], a[48:51]
v_mfma_f32_16x16x32_bf16 a[68:71], v[80:83], v[124:127], a[68:71]
v_mfma_f32_16x16x32_bf16 a[12:15], v[84:87], v[112:115], a[12:15]
v_mfma_f32_16x16x32_bf16 a[32:35], v[84:87], v[116:119], a[32:35]
v_mfma_f32_16x16x32_bf16 a[52:55], v[84:87], v[120:123], a[52:55]
v_mfma_f32_16x16x32_bf16 a[72:75], v[84:87], v[124:127], a[72:75]
v_mfma_f32_16x16x32_bf16 a[16:19], v[88:91], v[112:115], a[16:19]
v_mfma_f32_16x16x32_bf16 a[36:39], v[88:91], v[116:119], a[36:39]
v_mfma_f32_16x16x32_bf16 a[56:59], v[88:91], v[120:123], a[56:59]
v_mfma_f32_16x16x32_bf16 a[76:79], v[88:91], v[124:127], a[76:79]
s_waitcnt vmcnt(8)
s_waitcnt lgkmcnt(0)
v_mfma_f32_16x16x32_bf16 a[0:3], v[92:95], v[128:131], a[0:3]
v_mfma_f32_16x16x32_bf16 a[20:23], v[92:95], v[132:135], a[20:23]
v_mfma_f32_16x16x32_bf16 a[40:43], v[92:95], v[136:139], a[40:43]
v_mfma_f32_16x16x32_bf16 a[60:63], v[92:95], v[140:143], a[60:63]
v_mfma_f32_16x16x32_bf16 a[4:7], v[96:99], v[128:131], a[4:7]
v_mfma_f32_16x16x32_bf16 a[24:27], v[96:99], v[132:135], a[24:27]
v_mfma_f32_16x16x32_bf16 a[44:47], v[96:99], v[136:139], a[44:47]
v_mfma_f32_16x16x32_bf16 a[64:67], v[96:99], v[140:143], a[64:67]
v_mfma_f32_16x16x32_bf16 a[8:11], v[100:103], v[128:131], a[8:11]
v_mfma_f32_16x16x32_bf16 a[28:31], v[100:103], v[132:135], a[28:31]
v_mfma_f32_16x16x32_bf16 a[48:51], v[100:103], v[136:139], a[48:51]
v_mfma_f32_16x16x32_bf16 a[68:71], v[100:103], v[140:143], a[68:71]
v_mfma_f32_16x16x32_bf16 a[12:15], v[104:107], v[128:131], a[12:15]
v_mfma_f32_16x16x32_bf16 a[32:35], v[104:107], v[132:135], a[32:35]
v_mfma_f32_16x16x32_bf16 a[52:55], v[104:107], v[136:139], a[52:55]
v_mfma_f32_16x16x32_bf16 a[72:75], v[104:107], v[140:143], a[72:75]
v_mfma_f32_16x16x32_bf16 a[16:19], v[108:111], v[128:131], a[16:19]
v_mfma_f32_16x16x32_bf16 a[36:39], v[108:111], v[132:135], a[36:39]
v_mfma_f32_16x16x32_bf16 a[56:59], v[108:111], v[136:139], a[56:59]
v_mfma_f32_16x16x32_bf16 a[76:79], v[108:111], v[140:143], a[76:79]
s_waitcnt vmcnt(4)
s_waitcnt lgkmcnt(0)
v_mfma_f32_16x16x32_bf16 a[0:3], v[12:15], v[144:147], a[0:3]
v_mfma_f32_16x16x32_bf16 a[20:23], v[12:15], v[148:151], a[20:23]
v_mfma_f32_16x16x32_bf16 a[40:43], v[12:15], v[152:155], a[40:43]
v_mfma_f32_16x16x32_bf16 a[60:63], v[12:15], v[156:159], a[60:63]
v_mfma_f32_16x16x32_bf16 a[4:7], v[16:19], v[144:147], a[4:7]
v_mfma_f32_16x16x32_bf16 a[24:27], v[16:19], v[148:151], a[24:27]
v_mfma_f32_16x16x32_bf16 a[44:47], v[16:19], v[152:155], a[44:47]
v_mfma_f32_16x16x32_bf16 a[64:67], v[16:19], v[156:159], a[64:67]
v_mfma_f32_16x16x32_bf16 a[8:11], v[20:23], v[144:147], a[8:11]
v_mfma_f32_16x16x32_bf16 a[28:31], v[20:23], v[148:151], a[28:31]
v_mfma_f32_16x16x32_bf16 a[48:51], v[20:23], v[152:155], a[48:51]
v_mfma_f32_16x16x32_bf16 a[68:71], v[20:23], v[156:159], a[68:71]
v_mfma_f32_16x16x32_bf16 a[12:15], v[24:27], v[144:147], a[12:15]
v_mfma_f32_16x16x32_bf16 a[32:35], v[24:27], v[148:151], a[32:35]
v_mfma_f32_16x16x32_bf16 a[52:55], v[24:27], v[152:155], a[52:55]
v_mfma_f32_16x16x32_bf16 a[72:75], v[24:27], v[156:159], a[72:75]
v_mfma_f32_16x16x32_bf16 a[16:19], v[28:31], v[144:147], a[16:19]
v_mfma_f32_16x16x32_bf16 a[36:39], v[28:31], v[148:151], a[36:39]
v_mfma_f32_16x16x32_bf16 a[56:59], v[28:31], v[152:155], a[56:59]
v_mfma_f32_16x16x32_bf16 a[76:79], v[28:31], v[156:159], a[76:79]
s_waitcnt vmcnt(0)
s_waitcnt lgkmcnt(0)
v_mfma_f32_16x16x32_bf16 a[0:3], v[32:35], v[160:163], a[0:3]
v_mfma_f32_16x16x32_bf16 a[20:23], v[32:35], v[164:167], a[20:23]
v_mfma_f32_16x16x32_bf16 a[40:43], v[32:35], v[168:171], a[40:43]
v_mfma_f32_16x16x32_bf16 a[60:63], v[32:35], v[172:175], a[60:63]
v_mfma_f32_16x16x32_bf16 a[4:7], v[36:39], v[160:163], a[4:7]
v_mfma_f32_16x16x32_bf16 a[24:27], v[36:39], v[164:167], a[24:27]
v_mfma_f32_16x16x32_bf16 a[44:47], v[36:39], v[168:171], a[44:47]
v_mfma_f32_16x16x32_bf16 a[64:67], v[36:39], v[172:175], a[64:67]
v_mfma_f32_16x16x32_bf16 a[8:11], v[40:43], v[160:163], a[8:11]
v_mfma_f32_16x16x32_bf16 a[28:31], v[40:43], v[164:167], a[28:31]
v_mfma_f32_16x16x32_bf16 a[48:51], v[40:43], v[168:171], a[48:51]
v_mfma_f32_16x16x32_bf16 a[68:71], v[40:43], v[172:175], a[68:71]
v_mfma_f32_16x16x32_bf16 a[12:15], v[44:47], v[160:163], a[12:15]
v_mfma_f32_16x16x32_bf16 a[32:35], v[44:47], v[164:167], a[32:35]
v_mfma_f32_16x16x32_bf16 a[52:55], v[44:47], v[168:171], a[52:55]
v_mfma_f32_16x16x32_bf16 a[72:75], v[44:47], v[172:175], a[72:75]
v_mfma_f32_16x16x32_bf16 a[16:19], v[48:51], v[160:163], a[16:19]
v_mfma_f32_16x16x32_bf16 a[36:39], v[48:51], v[164:167], a[36:39]
v_mfma_f32_16x16x32_bf16 a[56:59], v[48:51], v[168:171], a[56:59]
v_mfma_f32_16x16x32_bf16 a[76:79], v[48:51], v[172:175], a[76:79]
s_barrier
s_add_u32 s50, s58, 1
s_and_b32 s50, s50, 3
s_mul_i32 s50, s50, 15360
s_add_u32 s50, s50, 0
v_add_u32 v4, s50, v8
s_add_u32 s50, s58, 2
s_and_b32 s50, s50, 3
s_mul_i32 s50, s50, 15360
s_add_u32 s50, s50, 5120
v_add_u32 v5, s50, v8
s_add_u32 s50, s58, 3
s_and_b32 s50, s50, 3
s_mul_i32 s50, s50, 15360
s_add_u32 s50, s50, 10240
v_add_u32 v6, s50, v8
ds_read_b64_tr_b16 v[100:101], v9 offset:0
ds_read_b128 v[36:39], v11 offset:0
ds_read_b64_tr_b16 v[102:103], v9 offset:2048
ds_read_b128 v[40:43], v11 offset:64
ds_read_b64_tr_b16 v[104:105], v9 offset:4096
ds_read_b128 v[44:47], v11 offset:128
ds_read_b64_tr_b16 v[106:107], v9 offset:6144
ds_read_b128 v[48:51], v11 offset:192
ds_read_b64_tr_b16 v[108:109], v9 offset:8192
ds_read_b128 v[52:55], v11 offset:256
ds_write_b128 v4, a[20:23] offset:0
ds_write_b128 v4, a[24:27] offset:1024
ds_write_b128 v4, a[28:31] offset:2048
ds_write_b128 v4, a[32:35] offset:3072
ds_write_b128 v4, a[36:39] offset:4096
ds_write_b128 v5, a[40:43] offset:0
ds_write_b128 v5, a[44:47] offset:1024
ds_write_b128 v5, a[48:51] offset:2048
ds_write_b128 v5, a[52:55] offset:3072
ds_write_b128 v5, a[56:59] offset:4096
ds_write_b128 v6, a[60:63] offset:0
ds_write_b128 v6, a[64:67] offset:1024
ds_write_b128 v6, a[68:71] offset:2048
ds_write_b128 v6, a[72:75] offset:3072
ds_write_b128 v6, a[76:79] offset:4096
v_accvgpr_read_b32 v16, a0
v_accvgpr_read_b32 v17, a1
v_accvgpr_read_b32 v18, a2
v_accvgpr_read_b32 v19, a3
v_accvgpr_read_b32 v20, a4
v_accvgpr_read_b32 v21, a5
v_accvgpr_read_b32 v22, a6
v_accvgpr_read_b32 v23, a7
v_accvgpr_read_b32 v24, a8
v_accvgpr_read_b32 v25, a9
v_accvgpr_read_b32 v26, a10
v_accvgpr_read_b32 v27, a11
v_accvgpr_read_b32 v28, a12
v_accvgpr_read_b32 v29, a13
v_accvgpr_read_b32 v30, a14
v_accvgpr_read_b32 v31, a15
v_accvgpr_read_b32 v32, a16
v_accvgpr_read_b32 v33, a17
v_accvgpr_read_b32 v34, a18
v_accvgpr_read_b32 v35, a19
s_waitcnt lgkmcnt(0)
s_barrier
ds_read_b128 v[112:115], v10 offset:0
ds_read_b128 v[116:119], v10 offset:1024
ds_read_b128 v[120:123], v10 offset:2048
ds_read_b128 v[124:127], v10 offset:3072
ds_read_b128 v[128:131], v10 offset:4096
ds_read_b128 v[132:135], v10 offset:5120
ds_read_b128 v[136:139], v10 offset:6144
ds_read_b128 v[140:143], v10 offset:7168
ds_read_b128 v[144:147], v10 offset:8192
ds_read_b128 v[148:151], v10 offset:9216
ds_read_b128 v[152:155], v10 offset:10240
ds_read_b128 v[156:159], v10 offset:11264
ds_read_b128 v[160:163], v10 offset:12288
ds_read_b128 v[164:167], v10 offset:13312
ds_read_b128 v[168:171], v10 offset:14336
v_lshlrev_b32 v60, 16, v100
v_and_b32 v61, 0xffff0000, v100
v_lshlrev_b32 v62, 16, v101
v_and_b32 v63, 0xffff0000, v101
v_lshlrev_b32 v64, 16, v102
v_and_b32 v65, 0xffff0000, v102
v_lshlrev_b32 v66, 16, v103
v_and_b32 v67, 0xffff0000, v103
v_lshlrev_b32 v68, 16, v104
v_and_b32 v69, 0xffff0000, v104
v_lshlrev_b32 v70, 16, v105
v_and_b32 v71, 0xffff0000, v105
v_lshlrev_b32 v72, 16, v106
v_and_b32 v73, 0xffff0000, v106
v_lshlrev_b32 v74, 16, v107
v_and_b32 v75, 0xffff0000, v107
v_lshlrev_b32 v76, 16, v108
v_and_b32 v77, 0xffff0000, v108
v_lshlrev_b32 v78, 16, v109
v_and_b32 v79, 0xffff0000, v109
s_waitcnt lgkmcnt(10)
v_add_f32 v16, v16, v112
v_add_f32 v17, v17, v113
v_add_f32 v18, v18, v114
v_add_f32 v19, v19, v115
v_add_f32 v20, v20, v116
v_add_f32 v21, v21, v117
v_add_f32 v22, v22, v118
v_add_f32 v23, v23, v119
v_add_f32 v24, v24, v120
v_add_f32 v25, v25, v121
v_add_f32 v26, v26, v122
v_add_f32 v27, v27, v123
v_add_f32 v28, v28, v124
v_add_f32 v29, v29, v125
v_add_f32 v30, v30, v126
v_add_f32 v31, v31, v127
v_add_f32 v32, v32, v128
v_add_f32 v33, v33, v129
v_add_f32 v34, v34, v130
v_add_f32 v35, v35, v131
s_waitcnt lgkmcnt(5)
v_add_f32 v16, v16, v132
v_add_f32 v17, v17, v133
v_add_f32 v18, v18, v134
v_add_f32 v19, v19, v135
v_add_f32 v20, v20, v136
v_add_f32 v21, v21, v137
v_add_f32 v22, v22, v138
v_add_f32 v23, v23, v139
v_add_f32 v24, v24, v140
v_add_f32 v25, v25, v141
v_add_f32 v26, v26, v142
v_add_f32 v27, v27, v143
v_add_f32 v28, v28, v144
v_add_f32 v29, v29, v145
v_add_f32 v30, v30, v146
v_add_f32 v31, v31, v147
v_add_f32 v32, v32, v148
v_add_f32 v33, v33, v149
v_add_f32 v34, v34, v150
v_add_f32 v35, v35, v151
s_waitcnt lgkmcnt(0)
v_add_f32 v16, v16, v152
v_add_f32 v17, v17, v153
v_add_f32 v18, v18, v154
v_add_f32 v19, v19, v155
v_add_f32 v20, v20, v156
v_add_f32 v21, v21, v157
v_add_f32 v22, v22, v158
v_add_f32 v23, v23, v159
v_add_f32 v24, v24, v160
v_add_f32 v25, v25, v161
v_add_f32 v26, v26, v162
v_add_f32 v27, v27, v163
v_add_f32 v28, v28, v164
v_add_f32 v29, v29, v165
v_add_f32 v30, v30, v166
v_add_f32 v31, v31, v167
v_add_f32 v32, v32, v168
v_add_f32 v33, v33, v169
v_add_f32 v34, v34, v170
v_add_f32 v35, v35, v171
v_fma_f32 v60, v36, v16, v60
v_fma_f32 v61, v37, v17, v61
v_fma_f32 v62, v38, v18, v62
v_fma_f32 v63, v39, v19, v63
v_cvt_pk_bf16_f32 v160, v60, v61
v_cvt_pk_bf16_f32 v161, v62, v63
buffer_store_dwordx2 v[160:161], v7, s[76:79], 0 offen offset:0
v_fma_f32 v64, v40, v20, v64
v_fma_f32 v65, v41, v21, v65
v_fma_f32 v66, v42, v22, v66
v_fma_f32 v67, v43, v23, v67
v_cvt_pk_bf16_f32 v162, v64, v65
v_cvt_pk_bf16_f32 v163, v66, v67
buffer_store_dwordx2 v[162:163], v7, s[76:79], 0 offen offset:32
v_fma_f32 v68, v44, v24, v68
v_fma_f32 v69, v45, v25, v69
v_fma_f32 v70, v46, v26, v70
v_fma_f32 v71, v47, v27, v71
v_cvt_pk_bf16_f32 v164, v68, v69
v_cvt_pk_bf16_f32 v165, v70, v71
buffer_store_dwordx2 v[164:165], v7, s[76:79], 0 offen offset:64
v_fma_f32 v72, v48, v28, v72
v_fma_f32 v73, v49, v29, v73
v_fma_f32 v74, v50, v30, v74
v_fma_f32 v75, v51, v31, v75
v_cvt_pk_bf16_f32 v166, v72, v73
v_cvt_pk_bf16_f32 v167, v74, v75
buffer_store_dwordx2 v[166:167], v7, s[76:79], 0 offen offset:96
v_fma_f32 v76, v52, v32, v76
v_fma_f32 v77, v53, v33, v77
v_fma_f32 v78, v54, v34, v78
v_fma_f32 v79, v55, v35, v79
v_cvt_pk_bf16_f32 v168, v76, v77
v_cvt_pk_bf16_f32 v169, v78, v79
buffer_store_dwordx2 v[168:169], v7, s[76:79], 0 offen offset:128
s_endpgm
k34_exit:
s_endpgm
s_endpgm
.p2align 4
.type k1_tab_w,@object
k1_tab_w:
.long 0, 1024, 1032, 2048
.long 32, 1040, 1048, 2052
.long 64, 1056, 1064, 2056
.long 96, 1072, 1080, 2060
.long 128, 1088, 1096, 2064
.long 160, 1104, 1112, 2068
.long 192, 1120, 1128, 2072
.long 224, 1136, 1144, 2076
.long 256, 1152, 1160, 2080
.long 288, 1168, 1176, 2084
.long 320, 1184, 1192, 2088
.long 352, 1200, 1208, 2092
.long 384, 1216, 1224, 2096
.long 416, 1232, 1240, 2100
.long 448, 1248, 1256, 2104
.long 480, 1264, 1272, 2108
.long 16, 1280, 1288, 2304
.long 48, 1296, 1304, 2308
.long 80, 1312, 1320, 2312
.long 112, 1328, 1336, 2316
.long 144, 1344, 1352, 2320
.long 176, 1360, 1368, 2324
.long 208, 1376, 1384, 2328
.long 240, 1392, 1400, 2332
.long 272, 1408, 1416, 2336
.long 304, 1424, 1432, 2340
.long 336, 1440, 1448, 2344
.long 368, 1456, 1464, 2348
.long 400, 1472, 1480, 2352
.long 432, 1488, 1496, 2356
.long 464, 1504, 1512, 2360
.long 496, 1520, 1528, 2364
.long 512, 1536, 1664, 2560
.long 544, 1544, 1672, 2564
.long 576, 1552, 1680, 2568
.long 608, 1560, 1688, 2572
.long 640, 1568, 1696, 2576
.long 672, 1576, 1704, 2580
.long 704, 1584, 1712, 2584
.long 736, 1592, 1720, 2588
.long 768, 1600, 1728, 2592
.long 800, 1608, 1736, 2596
.long 832, 1616, 1744, 2600
.long 864, 1624, 1752, 2604
.long 896, 1632, 1760, 2608
.long 928, 1640, 1768, 2612
.long 960, 1648, 1776, 2616
.long 992, 1656, 1784, 2620
.long 528, 1792, 1920, 2816
.long 560, 1800, 1928, 2820
.long 592, 1808, 1936, 2824
.long 624, 1816, 1944, 2828
.long 656, 1824, 1952, 2832
.long 688, 1832, 1960, 2836
.long 720, 1840, 1968, 2840
.long 752, 1848, 1976, 2844
.long 784, 1856, 1984, 2848
.long 816, 1864, 1992, 2852
.long 848, 1872, 2000, 2856
.long 880, 1880, 2008, 2860
.long 912, 1888, 2016, 2864
.long 944, 1896, 2024, 2868
.long 976, 1904, 2032, 2872
.long 1008, 1912, 2040, 2876
.type k1_tab_g,@object
k1_tab_g:
.short 26336, 26338, 26340, 26342, 26344, 26346, 26348, 26350
.short 26352, 26354, 26356, 26358, 26360, 26362, 26364, 26366
.short 26368, 26370, 26372, 26374, 26376, 26378, 26380, 26382
.short 26384, 26386, 26388, 26390, 26392, 26394, 26396, 26398
.short 26400, 26402, 26404, 26406, 26408, 26410, 26412, 26414
.short 26416, 26418, 26420, 26422, 26424, 26426, 26428, 26430
.short 26432, 26434, 26436, 26438, 26440, 26442, 26444, 26446
.short 26448, 26450, 26452, 26454, 26456, 26458, 26460, 26462
.short 26464, 26466, 26468, 26470, 26472, 26474, 26476, 26478
.short 26480, 26482, 26484, 26486, 26488, 26490, 26492, 26494
.short 26496, 26498, 26500, 26502, 26504, 26506, 26508, 26510
.short 26512, 26514, 26516, 26518, 26520, 26522, 26524, 26526
.short 26528, 26530, 26532, 26534, 26536, 26538, 26540, 26542
.short 26544, 26546, 26548, 26550, 26552, 26554, 26556, 26558
.short 26560, 26562, 26564, 26566, 26568, 26570, 26572, 26574
.short 26576, 26578, 26580, 26582, 26584, 26586, 26588, 26590
.short 26592, 26594, 26596, 26598, 26600, 26602, 26604, 26606
.short 26608, 26610, 26612, 26614, 26616, 26618, 26620, 26622
.short 26624, 26626, 26628, 26630, 26632, 26634, 26636, 26638
.short 26640, 26642, 26644, 26646, 26648, 26650, 26652, 26654
.short 26656, 26658, 26660, 26662, 26664, 26666, 26668, 26670
.short 26672, 26674, 26676, 26678, 26680, 26682, 26684, 26686
.short 26688, 26690, 26692, 26694, 26696, 26698, 26700, 26702
.short 26704, 26706, 26708, 26710, 26712, 26714, 26716, 26718
.short 26720, 26722, 26724, 26726, 26728, 26730, 26732, 26734
.short 26736, 26738, 26740, 26742, 26744, 26746, 26748, 26750
.short 26752, 26754, 26756, 26758, 26760, 26762, 26764, 26766
.short 26768, 26770, 26772, 26774, 26776, 26778, 26780, 26782
.short 26784, 26786, 26788, 26790, 26792, 26794, 26796, 26798
.short 26800, 26802, 26804, 26806, 26808, 26810, 26812, 26814
.short 26816, 26818, 26820, 26822, 26824, 26826, 26828, 26830
.short 26832, 26834, 26836, 26838, 26840, 26842, 26844, 26846
.short 26848, 26848, 26850, 26852, 26852, 26852, 26854, 26856
.short 26856, 26856, 26858, 26860, 26860, 26860, 26862, 26864
.short 26864, 26864, 26866, 26868, 26868, 26868, 26870, 26872
.short 26872, 26872, 26874, 26876, 26876, 26876, 26878, 26880
.short 26880, 26880, 26882, 26884, 26884, 26884, 26886, 26888
.short 26888, 26888, 26890, 26892, 26892, 26892, 26894, 26896
.short 26896, 26896, 26898, 26900, 26900, 26900, 26902, 26904
.short 26904, 26904, 26906, 26908, 26908, 26908, 26910, 26912
.short 26912, 26912, 26914, 26916, 26916, 26916, 26918, 26920
.short 26920, 26920, 26922, 26924, 26924, 26924, 26926, 26928
.short 26928, 26928, 26930, 26932, 26932, 26932, 26934, 26936
.short 26936, 26936, 26938, 26940, 26940, 26940, 26942, 26944
.short 26944, 26944, 26946, 26948, 26948, 26948, 26950, 26952
.short 26952, 26952, 26954, 26956, 26956, 26956, 26958, 26960
.short 26960, 26960, 26962, 26964, 26964, 26964, 26966, 26968
.short 26968, 26968, 26970, 26972, 26972, 26972, 26974, 26976
.short 26976, 26976, 26978, 26980, 26980, 26980, 26982, 26984
.short 26984, 26984, 26986, 26988, 26988, 26988, 26990, 26992
.short 26992, 26992, 26994, 26996, 26996, 26996, 26998, 27000
.short 27000, 27000, 27002, 27004, 27004, 27004, 27006, 27008
.short 27008, 27008, 27010, 27012, 27012, 27012, 27014, 27016
.short 27016, 27016, 27018, 27020, 27020, 27020, 27022, 27024
.short 27024, 27024, 27026, 27028, 27028, 27028, 27030, 27032
.short 27032, 27032, 27034, 27036, 27036, 27036, 27038, 27040
.short 27040, 27040, 27042, 27044, 27044, 27044, 27046, 27048
.short 27048, 27048, 27050, 27052, 27052, 27052, 27054, 27056
.short 27056, 27056, 27058, 27060, 27060, 27060, 27062, 27064
.short 27064, 27064, 27066, 27068, 27068, 27068, 27070, 27072
.short 27072, 27072, 27074, 27076, 27076, 27076, 27078, 27080
.short 27080, 27080, 27082, 27084, 27084, 27084, 27086, 27088
.short 27088, 27088, 27090, 27092, 27092, 27092, 27094, 27096
.short 27096, 27096, 27098, 27100, 27100, 27100, 27102, 27104
.short 27104, 27104, 27104, 27106, 27106, 27106, 27108, 27108
.short 27108, 27108, 27108, 27110, 27110, 27110, 27112, 27112
.short 27112, 27112, 27112, 27114, 27114, 27114, 27116, 27116
.short 27116, 27116, 27116, 27118, 27118, 27118, 27120, 27120
.short 27120, 27120, 27120, 27122, 27122, 27122, 27124, 27124
.short 27124, 27124, 27124, 27126, 27126, 27126, 27128, 27128
.short 27128, 27128, 27128, 27130, 27130, 27130, 27132, 27132
.short 27132, 27132, 27132, 27134, 27134, 27134, 27136, 27136
.short 27136, 27136, 27136, 27138, 27138, 27138, 27140, 27140
.short 27140, 27140, 27140, 27142, 27142, 27142, 27144, 27144
.short 27144, 27144, 27144, 27146, 27146, 27146, 27148, 27148
.short 27148, 27148, 27148, 27150, 27150, 27150, 27152, 27152
.short 27152, 27152, 27152, 27154, 27154, 27154, 27156, 27156
.short 27156, 27156, 27156, 27158, 27158, 27158, 27160, 27160
.short 27160, 27160, 27160, 27162, 27162, 27162, 27164, 27164
.short 27164, 27164, 27164, 27166, 27166, 27166, 27168, 27168
.short 27168, 27168, 27168, 27170, 27170, 27170, 27172, 27172
.short 27172, 27172, 27172, 27174, 27174, 27174, 27176, 27176
.short 27176, 27176, 27176, 27178, 27178, 27178, 27180, 27180
.short 27180, 27180, 27180, 27182, 27182, 27182, 27184, 27184
.short 27184, 27184, 27184, 27186, 27186, 27186, 27188, 27188
.short 27188, 27188, 27188, 27190, 27190, 27190, 27192, 27192
.short 27192, 27192, 27192, 27194, 27194, 27194, 27196, 27196
.short 27196, 27196, 27196, 27198, 27198, 27198, 27200, 27200
.short 27200, 27200, 27200, 27202, 27202, 27202, 27204, 27204
.short 27204, 27204, 27204, 27206, 27206, 27206, 27208, 27208
.short 27208, 27208, 27208, 27210, 27210, 27210, 27212, 27212
.short 27212, 27212, 27212, 27214, 27214, 27214, 27216, 27216
.short 27216, 27216, 27216, 27218, 27218, 27218, 27220, 27220
.short 27220, 27220, 27220, 27222, 27222, 27222, 27224, 27224
.short 27224, 27224, 27224, 27226, 27226, 27226, 27228, 27228
.short 27228, 27228, 27228, 27230, 27230, 27230, 27232, 27232
.short 27232, 27232, 27232, 27234, 27234, 27234, 27236, 27236
.short 27236, 27236, 27236, 27238, 27238, 27238, 27240, 27240
.short 27240, 27240, 27240, 27242, 27242, 27242, 27244, 27244
.short 27244, 27244, 27244, 27246, 27246, 27246, 27248, 27248
.short 27248, 27248, 27248, 27250, 27250, 27250, 27252, 27252
.short 27252, 27252, 27252, 27254, 27254, 27254, 27256, 27256
.short 27256, 27256, 27256, 27258, 27258, 27258, 27260, 27260
.short 27260, 27260, 27260, 27262, 27262, 27262, 27264, 27264
.short 27264, 27264, 27264, 27266, 27266, 27266, 27268, 27268
.short 27268, 27268, 27268, 27270, 27270, 27270, 27272, 27272
.short 27272, 27272, 27272, 27274, 27274, 27274, 27276, 27276
.short 27276, 27276, 27276, 27278, 27278, 27278, 27280, 27280
.short 27280, 27280, 27280, 27282, 27282, 27282, 27284, 27284
.short 27284, 27284, 27284, 27286, 27286, 27286, 27288, 27288
.short 27288, 27288, 27288, 27290, 27290, 27290, 27292, 27292
.short 27292, 27292, 27292, 27294, 27294, 27294, 27296, 27296
.short 27296, 27296, 27296, 27298, 27298, 27298, 27300, 27300
.short 27300, 27300, 27300, 27302, 27302, 27302, 27304, 27304
.short 27304, 27304, 27304, 27306, 27306, 27306, 27308, 27308
.short 27308, 27308, 27308, 27310, 27310, 27310, 27312, 27312
.short 27312, 27312, 27312, 27314, 27314, 27314, 27316, 27316
.short 27316, 27316, 27316, 27318, 27318, 27318, 27320, 27320
.short 27320, 27320, 27320, 27322, 27322, 27322, 27324, 27324
.short 27324, 27324, 27324, 27326, 27326, 27326, 27328, 27328
.short 27328, 27328, 27328, 27330, 27330, 27330, 27332, 27332
.short 27332, 27332, 27332, 27334, 27334, 27334, 27336, 27336
.short 27336, 27336, 27336, 27338, 27338, 27338, 27340, 27340
.short 27340, 27340, 27340, 27342, 27342, 27342, 27344, 27344
.short 27344, 27344, 27344, 27346, 27346, 27346, 27348, 27348
.short 27348, 27348, 27348, 27350, 27350, 27350, 27352, 27352
.short 27352, 27352, 27352, 27354, 27354, 27354, 27356, 27356
.short 27356, 27356, 27356, 27358, 27358, 27358, 27360, 27360
.short 27360, 27360, 27360, 27360, 27360, 27362, 27362, 27362
.short 27362, 27362, 27362, 27362, 27364, 27364, 27364, 27364
.short 27364, 27364, 27364, 27364, 27364, 27366, 27366, 27366
.short 27366, 27366, 27366, 27366, 27368, 27368, 27368, 27368
.short 27368, 27368, 27368, 27368, 27368, 27370, 27370, 27370
.short 27370, 27370, 27370, 27370, 27372, 27372, 27372, 27372
.short 27372, 27372, 27372, 27372, 27372, 27374, 27374, 27374
.short 27374, 27374, 27374, 27374, 27376, 27376, 27376, 27376
.short 27376, 27376, 27376, 27376, 27376, 27378, 27378, 27378
.short 27378, 27378, 27378, 27378, 27380, 27380, 27380, 27380
.short 27380, 27380, 27380, 27380, 27380, 27382, 27382, 27382
.short 27382, 27382, 27382, 27382, 27384, 27384, 27384, 27384
.short 27384, 27384, 27384, 27384, 27384, 27386, 27386, 27386
.short 27386, 27386, 27386, 27386, 27388, 27388, 27388, 27388
.short 27388, 27388, 27388, 27388, 27388, 27390, 27390, 27390
.short 27390, 27390, 27390, 27390, 27392, 27392, 27392, 27392
.short 27392, 27392, 27392, 27392, 27392, 27394, 27394, 27394
.short 27394, 27394, 27394, 27394, 27396, 27396, 27396, 27396
.short 27396, 27396, 27396, 27396, 27396, 27398, 27398, 27398
.short 27398, 27398, 27398, 27398, 27400, 27400, 27400, 27400
.short 27400, 27400, 27400, 27400, 27400, 27402, 27402, 27402
.short 27402, 27402, 27402, 27402, 27404, 27404, 27404, 27404
.short 27404, 27404, 27404, 27404, 27404, 27406, 27406, 27406
.short 27406, 27406, 27406, 27406, 27408, 27408, 27408, 27408
.short 27408, 27408, 27408, 27408, 27408, 27410, 27410, 27410
.short 27410, 27410, 27410, 27410, 27412, 27412, 27412, 27412
.short 27412, 27412, 27412, 27412, 27412, 27414, 27414, 27414
.short 27414, 27414, 27414, 27414, 27416, 27416, 27416, 27416
.short 27416, 27416, 27416, 27416, 27416, 27418, 27418, 27418
.short 27418, 27418, 27418, 27418, 27420, 27420, 27420, 27420
.short 27420, 27420, 27420, 27420, 27420, 27422, 27422, 27422
.short 27422, 27422, 27422, 27422, 27424, 27424, 27424, 27424
.short 27424, 27424, 27424, 27424, 27424, 27426, 27426, 27426
.short 27426, 27426, 27426, 27426, 27428, 27428, 27428, 27428
.short 27428, 27428, 27428, 27428, 27428, 27430, 27430, 27430
.short 27430, 27430, 27430, 27430, 27432, 27432, 27432, 27432
.short 27432, 27432, 27432, 27432, 27432, 27434, 27434, 27434
.short 27434, 27434, 27434, 27434, 27436, 27436, 27436, 27436
.short 27436, 27436, 27436, 27436, 27436, 27438, 27438, 27438
.short 27438, 27438, 27438, 27438, 27440, 27440, 27440, 27440
.short 27440, 27440, 27440, 27440, 27440, 27442, 27442, 27442
.short 27442, 27442, 27442, 27442, 27444, 27444, 27444, 27444
.short 27444, 27444, 27444, 27444, 27444, 27446, 27446, 27446
.short 27446, 27446, 27446, 27446, 27448, 27448, 27448, 27448
.short 27448, 27448, 27448, 27448, 27448, 27450, 27450, 27450
.short 27450, 27450, 27450, 27450, 27452, 27452, 27452, 27452
.short 27452, 27452, 27452, 27452, 27452, 27454, 27454, 27454
.short 27454, 27454, 27454, 27454, 27456, 27456, 27456, 27456
.short 27456, 27456, 27456, 27456, 27456, 27458, 27458, 27458
.short 27458, 27458, 27458, 27458, 27460, 27460, 27460, 27460
.short 27460, 27460, 27460, 27460, 27460, 27462, 27462, 27462
.short 27462, 27462, 27462, 27462, 27464, 27464, 27464, 27464
.short 27464, 27464, 27464, 27464, 27464, 27466, 27466, 27466
.short 27466, 27466, 27466, 27466, 27468, 27468, 27468, 27468
.short 27468, 27468, 27468, 27468, 27468, 27470, 27470, 27470
.short 27470, 27470, 27470, 27470, 27472, 27472, 27472, 27472
.short 27472, 27472, 27472, 27472, 27472, 27474, 27474, 27474
.short 27474, 27474, 27474, 27474, 27476, 27476, 27476, 27476
.short 27476, 27476, 27476, 27476, 27476, 27478, 27478, 27478
.short 27478, 27478, 27478, 27478, 27480, 27480, 27480, 27480
.short 27480, 27480, 27480, 27480, 27480, 27482, 27482, 27482
.short 27482, 27482, 27482, 27482, 27484, 27484, 27484, 27484
.short 27484, 27484, 27484, 27484, 27484, 27486, 27486, 27486
.short 27486, 27486, 27486, 27486, 27488, 27488, 27488, 27488
.short 27488, 27488, 27488, 27488, 27488, 27490, 27490, 27490
.short 27490, 27490, 27490, 27490, 27492, 27492, 27492, 27492
.short 27492, 27492, 27492, 27492, 27492, 27494, 27494, 27494
.short 27494, 27494, 27494, 27494, 27496, 27496, 27496, 27496
.short 27496, 27496, 27496, 27496, 27496, 27498, 27498, 27498
.short 27498, 27498, 27498, 27498, 27500, 27500, 27500, 27500
.short 27500, 27500, 27500, 27500, 27500, 27502, 27502, 27502
.short 27502, 27502, 27502, 27502, 27504, 27504, 27504, 27504
.short 27504, 27504, 27504, 27504, 27504, 27506, 27506, 27506
.short 27506, 27506, 27506, 27506, 27508, 27508, 27508, 27508
.short 27508, 27508, 27508, 27508, 27508, 27510, 27510, 27510
.short 27510, 27510, 27510, 27510, 27512, 27512, 27512, 27512
.short 27512, 27512, 27512, 27512, 27512, 27514, 27514, 27514
.short 27514, 27514, 27514, 27514, 27516, 27516, 27516, 27516
.short 27516, 27516, 27516, 27516, 27516, 27518, 27518, 27518
.short 27518, 27518, 27518, 27518, 27520, 27520, 27520, 27520
.short 27520, 27520, 27520, 27520, 27520, 27522, 27522, 27522
.short 27522, 27522, 27522, 27522, 27524, 27524, 27524, 27524
.short 27524, 27524, 27524, 27524, 27524, 27526, 27526, 27526
.short 27526, 27526, 27526, 27526, 27528, 27528, 27528, 27528
.short 27528, 27528, 27528, 27528, 27528, 27530, 27530, 27530
.short 27530, 27530, 27530, 27530, 27532, 27532, 27532, 27532
.short 27532, 27532, 27532, 27532, 27532, 27534, 27534, 27534
.short 27534, 27534, 27534, 27534, 27536, 27536, 27536, 27536
.short 27536, 27536, 27536, 27536, 27536, 27538, 27538, 27538
.short 27538, 27538, 27538, 27538, 27540, 27540, 27540, 27540
.short 27540, 27540, 27540, 27540, 27540, 27542, 27542, 27542
.short 27542, 27542, 27542, 27542, 27544, 27544, 27544, 27544
.short 27544, 27544, 27544, 27544, 27544, 27546, 27546, 27546
.short 27546, 27546, 27546, 27546, 27548, 27548, 27548, 27548
.short 27548, 27548, 27548, 27548, 27548, 27550, 27550, 27550
.short 27550, 27550, 27550, 27550, 27552, 27552, 27552, 27552
.short 27552, 27552, 27552, 27552, 27552, 27554, 27554, 27554
.short 27554, 27554, 27554, 27554, 27556, 27556, 27556, 27556
.short 27556, 27556, 27556, 27556, 27556, 27558, 27558, 27558
.short 27558, 27558, 27558, 27558, 27560, 27560, 27560, 27560
.short 27560, 27560, 27560, 27560, 27560, 27562, 27562, 27562
.short 27562, 27562, 27562, 27562, 27564, 27564, 27564, 27564
.short 27564, 27564, 27564, 27564, 27564, 27566, 27566, 27566
.short 27566, 27566, 27566, 27566, 27568, 27568, 27568, 27568
.short 27568, 27568, 27568, 27568, 27568, 27570, 27570, 27570
.short 27570, 27570, 27570, 27570, 27572, 27572, 27572, 27572
.short 27572, 27572, 27572, 27572, 27572, 27574, 27574, 27574
.short 27574, 27574, 27574, 27574, 27576, 27576, 27576, 27576
.short 27576, 27576, 27576, 27576, 27576, 27578, 27578, 27578
.short 27578, 27578, 27578, 27578, 27580, 27580, 27580, 27580
.short 27580, 27580, 27580, 27580, 27580, 27582, 27582, 27582
.short 27582, 27582, 27582, 27582, 27584, 27584, 27584, 27584
.short 27584, 27584, 27584, 27584, 27584, 27586, 27586, 27586
.short 27586, 27586, 27586, 27586, 27588, 27588, 27588, 27588
.short 27588, 27588, 27588, 27588, 27588, 27590, 27590, 27590
.short 27590, 27590, 27590, 27590, 27592, 27592, 27592, 27592
.short 27592, 27592, 27592, 27592, 27592, 27594, 27594, 27594
.short 27594, 27594, 27594, 27594, 27596, 27596, 27596, 27596
.short 27596, 27596, 27596, 27596, 27596, 27598, 27598, 27598
.short 27598, 27598, 27598, 27598, 27600, 27600, 27600, 27600
.short 27600, 27600, 27600, 27600, 27600, 27602, 27602, 27602
.short 27602, 27602, 27602, 27602, 27604, 27604, 27604, 27604
.short 27604, 27604, 27604, 27604, 27604, 27606, 27606, 27606
.short 27606, 27606, 27606, 27606, 27608, 27608, 27608, 27608
.short 27608, 27608, 27608, 27608, 27608, 27610, 27610, 27610
.short 27610, 27610, 27610, 27610, 27612, 27612, 27612, 27612
.short 27612, 27612, 27612, 27612, 27612, 27614, 27614, 27614
.short 27614, 27614, 27614, 27614, 27616, 27616, 27616, 27616
code_end:
.section .rodata,"a"
.p2align 6
.amdhsa_kernel k1_kernel
  .amdhsa_next_free_vgpr 96
  .amdhsa_next_free_sgpr 102
  .amdhsa_accum_offset 96
  .amdhsa_group_segment_fixed_size 0
  .amdhsa_kernarg_size 128
  .amdhsa_user_sgpr_count 2
  .amdhsa_user_sgpr_kernarg_segment_ptr 1
  .amdhsa_system_sgpr_workgroup_id_x 1
  .amdhsa_float_denorm_mode_32 3
.end_amdhsa_kernel
.text
.section .rodata,"a"
.p2align 6
.amdhsa_kernel k2_kernel
  .amdhsa_next_free_vgpr 128
  .amdhsa_next_free_sgpr 102
  .amdhsa_accum_offset 128
  .amdhsa_group_segment_fixed_size 0
  .amdhsa_kernarg_size 128
  .amdhsa_user_sgpr_count 2
  .amdhsa_user_sgpr_kernarg_segment_ptr 1
  .amdhsa_system_sgpr_workgroup_id_x 1
  .amdhsa_float_denorm_mode_32 3
.end_amdhsa_kernel
.text
.section .rodata,"a"
.p2align 6
.amdhsa_kernel k34_kernel
  .amdhsa_next_free_vgpr 256
  .amdhsa_next_free_sgpr 102
  .amdhsa_accum_offset 176
  .amdhsa_group_segment_fixed_size 0
  .amdhsa_kernarg_size 128
  .amdhsa_user_sgpr_count 2
  .amdhsa_user_sgpr_kernarg_segment_ptr 1
  .amdhsa_system_sgpr_workgroup_id_x 1
  .amdhsa_float_denorm_mode_32 3
.end_amdhsa_kernel
.text
```
